```python
import torch

def _softmax(x, axis=-1):
    return torch.softmax(x, dim=axis)
def _gelu(x):
    return torch.nn.functional.gelu(x, approximate="tanh")
def _silu(x):
    return torch.nn.functional.silu(x)
def _sigmoid(x):
    return torch.sigmoid(x)
def _layernorm(x, axis=-1, eps=1e-5):
    m = x.mean(dim=axis, keepdim=True)
    v = x.var(dim=axis, keepdim=True, unbiased=False)
    return (x - m) / torch.sqrt(v + eps)
def _scatter_add(tgt, idx, src, axis=0):
    return tgt.clone().index_add_(axis, idx, src)
def _segment_sum(src, seg, n):
    out = torch.zeros((n,) + src.shape[1:], dtype=src.dtype)
    return out.index_add_(0, seg, src)
def _pad(x, pw):
    flat = tuple(v for pair in reversed(pw) for v in pair)
    return torch.nn.functional.pad(x, flat)

kernel_name = 'gated_mix__linear_kernel_hedgehog__linear_kernel_hedgehog__prompt'

def setup_inputs():

    _w = (lambda a: (lambda t: t.to(torch.bfloat16) if t.is_floating_point() else t)(torch.as_tensor(a)))
    def _A_setup():
        B, S, D, H = 1, 2048, 448, 16
        Dh = D // H
        return {
            "x": _w((lambda *s: torch.randn(*s, dtype=torch.bfloat16) * 0.05)(B, S, D)),
            "wqkv": _w((lambda *s: torch.randn(*s, dtype=torch.bfloat16) * 0.8)(D, 3 * D)),
            "w_phi": _w((lambda *s: torch.randn(*s, dtype=torch.bfloat16) * 0.8)(H, Dh, Dh) * (Dh ** -0.5)),
            "wo": _w((lambda *s: torch.randn(*s, dtype=torch.bfloat16) * 0.05)(D, D)),
        }
    _A_in = _A_setup()

    def _B_setup():
        B, S, D, H = 1, 2048, 448, 16
        Dh = D // H
        return {
            "x": _w((lambda *s: torch.randn(*s, dtype=torch.bfloat16) * 0.05)(B, S, D)),
            "wqkv": _w((lambda *s: torch.randn(*s, dtype=torch.bfloat16) * 0.8)(D, 3 * D)),
            "w_phi": _w((lambda *s: torch.randn(*s, dtype=torch.bfloat16) * 0.8)(H, Dh, Dh) * (Dh ** -0.5)),
            "wo": _w((lambda *s: torch.randn(*s, dtype=torch.bfloat16) * 0.05)(D, D)),
        }
    _B_in = _B_setup()

    return {
        "A_x": _A_in["x"],
        "A_wqkv": _A_in["wqkv"],
        "A_w_phi": _A_in["w_phi"],
        "A_wo": _A_in["wo"],
        "B_x": _B_in["x"],
        "B_wqkv": _B_in["wqkv"],
        "B_w_phi": _B_in["w_phi"],
        "B_wo": _B_in["wo"],
        "gate_w": _w((lambda *s: torch.randn(*s, dtype=torch.bfloat16) * 0.05)(448) * 16.0),
    }

def reference(A_x, A_wqkv, A_w_phi, A_wo, B_x, B_wqkv, B_w_phi, B_wo, gate_w):
    def _A_ref(x, wqkv, w_phi, wo):
        B, S, D = x.shape
        H = 16; Dh = D // H
        qkv = (lambda x, *d: x.permute(*d))((x @ wqkv).reshape(B, S, 3, H, Dh), 2, 0, 3, 1, 4)
        q, k, v = qkv[0], qkv[1], qkv[2]
        pq = torch.einsum("bhsd,hdf->bhsf", q, w_phi)
        pk = torch.einsum("bhsd,hdf->bhsf", k, w_phi)
        phi_q = torch.concatenate([_softmax(pq, axis=-1), _softmax(-pq, axis=-1)], axis=-1)
        phi_k = torch.concatenate([_softmax(pk, axis=-1), _softmax(-pk, axis=-1)], axis=-1)
        kv = torch.einsum("bhsf,bhsd->bhfd", phi_k, v)
        z  = torch.einsum("bhsf->bhf", phi_k)
        num = torch.einsum("bhqf,bhfd->bhqd", phi_q, kv)
        den = torch.einsum("bhqf,bhf->bhq", phi_q, z)[..., None] + 1e-6
        o = num / den
        return (lambda x, *d: x.permute(*d))(o, 0, 2, 1, 3).reshape(B, S, D) @ wo

    def _B_ref(x, wqkv, w_phi, wo):
        B, S, D = x.shape
        H = 16; Dh = D // H
        qkv = (lambda x, *d: x.permute(*d))((x @ wqkv).reshape(B, S, 3, H, Dh), 2, 0, 3, 1, 4)
        q, k, v = qkv[0], qkv[1], qkv[2]
        pq = torch.einsum("bhsd,hdf->bhsf", q, w_phi)
        pk = torch.einsum("bhsd,hdf->bhsf", k, w_phi)
        phi_q = torch.concatenate([_softmax(pq, axis=-1), _softmax(-pq, axis=-1)], axis=-1)
        phi_k = torch.concatenate([_softmax(pk, axis=-1), _softmax(-pk, axis=-1)], axis=-1)
        kv = torch.einsum("bhsf,bhsd->bhfd", phi_k, v)
        z  = torch.einsum("bhsf->bhf", phi_k)
        num = torch.einsum("bhqf,bhfd->bhqd", phi_q, kv)
        den = torch.einsum("bhqf,bhf->bhq", phi_q, z)[..., None] + 1e-6
        o = num / den
        return (lambda x, *d: x.permute(*d))(o, 0, 2, 1, 3).reshape(B, S, D) @ wo

    x = A_x
    g = _sigmoid((x * gate_w).sum(-1, keepdims=True))
    a = _A_ref(x, A_wqkv, A_w_phi, A_wo)
    b = _B_ref(x, B_wqkv, B_w_phi, B_wo)
    return g * a + (1 - g) * b
```

```asm
; @launch grid=(256,1,1) block=(512,1,1) lds=163840
.amdgcn_target "amdgcn-amd-amdhsa--gfx950"
.text
.globl gated_mix__linear_kernel_hedgehog__linear_kernel_hedgehog__prompt_kernel
.p2align 8
.type gated_mix__linear_kernel_hedgehog__linear_kernel_hedgehog__prompt_kernel,@function
gated_mix__linear_kernel_hedgehog__linear_kernel_hedgehog__prompt_kernel:
  s_load_dwordx2 s[62:63], s[0:1], 0
  s_and_b32 s32, s2, 7
  s_lshr_b32 s33, s2, 3
  s_lshr_b32 s28, s32, 2
  s_lshl_b32 s34, s28, 5
  s_load_dwordx8 s[4:11], s[0:1], s34
  s_load_dwordx2 s[24:25], s[0:1], 88
  s_load_dwordx4 s[40:43], s[0:1], 64
  s_load_dwordx2 s[44:45], s[0:1], 24
  s_load_dwordx2 s[46:47], s[0:1], 56
  s_cmp_ge_u32 s2, 256
  s_cbranch_scc1 L_end
  s_getpc_b64 s[36:37]
L_pcref:
  s_lshr_b32 s35, s2, 3
  s_lshl_b32 s35, s35, 9
  v_lshlrev_b32 v30, 7, v0
  v_add_u32 v30, s35, v30
  v_cmp_gt_u32 vcc, 4, v0
  s_mov_b32 s35, L_end-L_pcref
  v_cmp_gt_u32 s[60:61], s35, v30
  s_nop 1
  s_and_b64 vcc, vcc, s[60:61]
  s_and_saveexec_b64 s[60:61], vcc
  s_cbranch_execz L_nopf
  global_load_dword v255, v30, s[36:37]
L_nopf:
  s_mov_b64 exec, -1
  v_and_b32 v1, 63, v0
  v_lshrrev_b32 v30, 6, v0
  s_bfe_u32 s35, s32, 0x10001
  s_and_b32 s36, s33, 7
  s_lshl_b32 s35, s35, 3
  s_add_u32 s29, s35, s36
  s_and_b32 s35, s32, 1
  s_lshl_b32 s35, s35, 2
  s_lshr_b32 s37, s33, 3
  s_add_u32 s30, s35, s37
  s_lshl_b32 s37, s37, 1
  s_add_u32 s68, s36, s37
  v_readfirstlane_b32 s31, v30
  s_cmp_ge_u32 s68, 7
  s_cselect_b32 s35, 7, 0
  s_sub_u32 s68, s68, s35
  s_cmp_ge_u32 s68, 7
  s_cselect_b32 s35, 7, 0
  s_sub_u32 s68, s68, s35
  s_lshl_b32 s69, s28, 4
  s_add_u32 s69, s69, s29
  s_cmp_ge_u32 s31, 4
  s_cbranch_scc0 L_nprio
  s_setprio 1
L_nprio:
  s_lshl_b32 s35, s30, 8
  s_lshl_b32 s36, s31, 5
  s_add_u32 s35, s35, s36
  s_mul_i32 s61, s35, 896
  v_lshrrev_b32 v30, 3, v1
  v_and_b32 v31, 7, v1
  v_lshrrev_b32 v2, 1, v30
  v_xor_b32 v31, v31, v2
  v_mul_u32_u24 v30, 896, v30
  v_add_u32 v30, s61, v30
  v_lshl_add_u32 v2, v31, 4, v30
  v_xor_b32 v31, 4, v31
  v_lshl_add_u32 v3, v31, 4, v30
  v_add_u32 v3, 6144, v3
  v_add_u32 v4, 12288, v2
  v_add_u32 v5, 12288, v3
  s_and_b32 s37, s31, 3
  s_lshl_b32 s67, s37, 10
  s_mul_i32 s36, s37, 43008
  s_mul_i32 s35, s29, 56
  s_add_u32 s35, s35, s36
  v_lshrrev_b32 v30, 2, v1
  v_and_b32 v31, 3, v1
  v_lshlrev_b32 v6, 4, v31
  v_cmp_eq_u32 vcc, 3, v31
  v_mul_u32_u24 v30, 2688, v30
  v_mov_b32 v31, 40
  s_lshl_b32 s56, s31, 12
  v_cndmask_b32 v6, v6, v31, vcc
  v_add3_u32 v6, v6, v30, s35
  v_lshlrev_b32 v7, 4, v1
  s_add_u32 s90, s68, 0
  s_cmp_ge_u32 s90, 7
  s_cselect_b32 s35, 7, 0
  s_sub_u32 s90, s90, s35
  s_lshl_b32 s90, s90, 7
  s_add_u32 s91, s68, 1
  s_cmp_ge_u32 s91, 7
  s_cselect_b32 s35, 7, 0
  s_sub_u32 s91, s91, s35
  s_lshl_b32 s91, s91, 7
  s_add_u32 s92, s68, 2
  s_cmp_ge_u32 s92, 7
  s_cselect_b32 s35, 7, 0
  s_sub_u32 s92, s92, s35
  s_lshl_b32 s92, s92, 7
  s_add_u32 s93, s68, 3
  s_cmp_ge_u32 s93, 7
  s_cselect_b32 s35, 7, 0
  s_sub_u32 s93, s93, s35
  s_lshl_b32 s93, s93, 7
  s_add_u32 s94, s68, 4
  s_cmp_ge_u32 s94, 7
  s_cselect_b32 s35, 7, 0
  s_sub_u32 s94, s94, s35
  s_lshl_b32 s94, s94, 7
  s_add_u32 s95, s68, 5
  s_cmp_ge_u32 s95, 7
  s_cselect_b32 s35, 7, 0
  s_sub_u32 s95, s95, s35
  s_lshl_b32 s95, s95, 7
  s_add_u32 s96, s68, 6
  s_cmp_ge_u32 s96, 7
  s_cselect_b32 s35, 7, 0
  s_sub_u32 s96, s96, s35
  s_lshl_b32 s96, s96, 7
  s_mul_i32 s32, s90, 1344
  s_add_u32 s32, s32, 896
  s_waitcnt lgkmcnt(0)
  s_mov_b32 s16, s6
  s_and_b32 s17, s7, 0xffff
  s_mov_b32 s18, 1204224
  s_mov_b32 s19, 0x20000
  s_mov_b32 m0, s67
  s_mov_b32 s12, s62
  s_and_b32 s13, s63, 0xffff
  s_cmp_ge_u32 s31, 4
  s_cbranch_scc1 L_now0
  buffer_load_dwordx4 v6, s[16:19], s32 offen lds
L_now0:
  s_mov_b32 s14, 1835008
  s_mov_b32 s15, 0x20000
  s_add_u32 m0, s56, 65536
  s_nop 0
  buffer_load_dwordx4 v2, s[12:15], s90 offen offset:0 lds
  buffer_load_dwordx4 v3, s[12:15], s90 offen offset:1024 lds
  buffer_load_dwordx4 v4, s[12:15], s90 offen offset:2048 lds
  buffer_load_dwordx4 v5, s[12:15], s90 offen offset:3072 lds
  s_mov_b32 s26, 0x10000000
  s_mov_b32 s27, 0x20000
  s_and_b32 s25, s25, 0xffff
  s_load_dword s48, s[24:25], 12
  s_cmp_ge_u32 s31, 2
  s_cbranch_scc1 L_nophi
  s_mul_i32 s34, s29, 1568
  s_add_u32 s20, s8, s34
  s_addc_u32 s21, s9, 0
  s_and_b32 s21, s21, 0xffff
  s_mov_b32 s22, 1568
  s_mov_b32 s23, 0x20000
  s_lshl_b32 s34, s31, 10
  s_add_u32 m0, s34, 28672
  s_nop 0
  buffer_load_dwordx4 v7, s[20:23], s34 offen lds
L_nophi:
  s_cmp_lg_u32 s69, 0
  s_cbranch_scc1 L_nogl
  s_mov_b32 s20, s40
  s_and_b32 s21, s41, 0xffff
  s_mov_b32 s22, 896
  s_mov_b32 s23, 0x20000
  v_lshrrev_b32 v30, 4, v1
  v_and_b32 v30, 1, v30
  v_lshlrev_b32 v30, 1, v30
  v_and_b32 v31, 15, v1
  s_and_b32 s34, s31, 3
  s_lshl_b32 s34, s34, 4
  v_add_u32 v31, s34, v31
  s_lshr_b32 s34, s31, 2
  s_add_u32 s34, s34, s68
  v_add_u32 v8, s34, v30
  v_subrev_u32 v9, 7, v8
  v_cmp_le_u32 vcc, 7, v8
  s_nop 1
  v_cndmask_b32 v8, v8, v9, vcc
  v_subrev_u32 v9, 7, v8
  v_cmp_le_u32 vcc, 7, v8
  s_nop 1
  v_cndmask_b32 v8, v8, v9, vcc
  v_lshl_add_u32 v8, v8, 6, v31
  v_lshlrev_b32 v8, 1, v8
  buffer_load_ushort v17, v8, s[20:23], 0 offen
  v_add_u32 v8, s34, v30
  v_add_u32 v8, 4, v8
  v_subrev_u32 v9, 7, v8
  v_cmp_le_u32 vcc, 7, v8
  s_nop 1
  v_cndmask_b32 v8, v8, v9, vcc
  v_subrev_u32 v9, 7, v8
  v_cmp_le_u32 vcc, 7, v8
  s_nop 1
  v_cndmask_b32 v8, v8, v9, vcc
  v_lshl_add_u32 v8, v8, 6, v31
  v_lshlrev_b32 v8, 1, v8
  buffer_load_ushort v27, v8, s[20:23], 0 offen
L_nogl:
  s_mov_b32 s4, s44
  s_and_b32 s5, s45, 0xffff
  s_mov_b32 s6, 401408
  s_mov_b32 s7, 0x20000
  s_mov_b32 s8, s46
  s_and_b32 s9, s47, 0xffff
  s_mov_b32 s10, 401408
  s_mov_b32 s11, 0x20000
  v_and_b32 v30, 31, v1
  v_lshrrev_b32 v31, 5, v1
  v_bfe_u32 v18, v30, 1, 3
  v_lshlrev_b32 v19, 7, v30
  s_add_u32 s34, s56, 32768
  v_add_u32 v19, s34, v19
  v_or_b32 v20, 0, v31
  v_xor_b32 v20, v20, v18
  v_lshl_add_u32 v8, v20, 4, v19
  v_add_u32 v12, 0x10000, v8
  v_or_b32 v20, 2, v31
  v_xor_b32 v20, v20, v18
  v_lshl_add_u32 v9, v20, 4, v19
  v_add_u32 v13, 0x10000, v9
  v_or_b32 v20, 4, v31
  v_xor_b32 v20, v20, v18
  v_lshl_add_u32 v10, v20, 4, v19
  v_add_u32 v14, 0x10000, v10
  v_or_b32 v20, 6, v31
  v_xor_b32 v20, v20, v18
  v_lshl_add_u32 v11, v20, 4, v19
  v_add_u32 v15, 0x10000, v11
  v_lshrrev_b32 v30, 4, v1
  v_bfe_u32 v31, v1, 2, 2
  v_and_b32 v28, 3, v1
  v_and_b32 v29, 1, v30
  v_lshl_add_u32 v22, v29, 2, v28
  v_lshlrev_b32 v23, 3, v22
  v_mov_b32 v24, 56
  v_cmp_eq_u32 vcc, 6, v22
  v_mov_b32 v25, 48
  v_lshrrev_b32 v26, 1, v30
  v_cndmask_b32 v23, v23, v24, vcc
  v_cmp_eq_u32 vcc, 7, v22
  v_lshl_add_u32 v24, v26, 3, v31
  s_nop 0
  v_cndmask_b32 v23, v23, v25, vcc
  v_lshl_add_u32 v16, v24, 6, v23
  v_mov_b32 v144, 0
  v_mov_b32 v145, 0
  v_mov_b32 v146, 0
  v_mov_b32 v147, 0
  v_mov_b32 v148, 0
  v_mov_b32 v149, 0
  v_mov_b32 v150, 0
  v_mov_b32 v151, 0
  v_mov_b32 v152, 0
  v_mov_b32 v153, 0
  v_mov_b32 v154, 0
  v_mov_b32 v155, 0
  v_mov_b32 v156, 0
  v_mov_b32 v157, 0
  v_mov_b32 v158, 0
  v_mov_b32 v159, 0
  v_mov_b32 v160, 0
  v_mov_b32 v161, 0
  v_mov_b32 v162, 0
  v_mov_b32 v163, 0
  v_mov_b32 v164, 0
  v_mov_b32 v165, 0
  v_mov_b32 v166, 0
  v_mov_b32 v167, 0
  v_mov_b32 v168, 0
  v_mov_b32 v169, 0
  v_mov_b32 v170, 0
  v_mov_b32 v171, 0
  v_mov_b32 v172, 0
  v_mov_b32 v173, 0
  v_mov_b32 v174, 0
  v_mov_b32 v175, 0
  s_mov_b32 s50, 1069066811
  s_mov_b32 s51, 1069066811
  s_mul_i32 s39, s31, 25088
  s_and_b32 s57, s31, 1
  s_bfe_u32 s58, s31, 0x10001
  s_lshr_b32 s59, s31, 2
  s_lshr_b32 s52, s2, 5
  s_lshr_b32 s53, s2, 3
  s_and_b32 s53, s53, 3
  s_and_b32 s34, s2, 7
  s_lshl_b32 s34, s34, 2
  s_add_u32 s53, s53, s34
  s_cmp_lt_u32 s31, 4
  s_cbranch_scc1 L_o_1
  s_mul_i32 s32, s91, 1344
  s_add_u32 m0, s67, 4096
  s_add_u32 s32, s32, 896
  buffer_load_dwordx4 v6, s[16:19], s32 offen lds
L_o_1:
  s_add_u32 m0, s56, 98304
  s_nop 0
  buffer_load_dwordx4 v2, s[12:15], s91 offen offset:0 lds
  buffer_load_dwordx4 v3, s[12:15], s91 offen offset:1024 lds
  buffer_load_dwordx4 v4, s[12:15], s91 offen offset:2048 lds
  buffer_load_dwordx4 v5, s[12:15], s91 offen offset:3072 lds
  s_cmp_lt_u32 s31, 4
  s_cbranch_scc0 L_o_2
  s_mul_i32 s32, s92, 1344
  s_add_u32 m0, s67, 8192
  s_add_u32 s32, s32, 896
  buffer_load_dwordx4 v6, s[16:19], s32 offen lds
L_o_2:
  s_add_u32 m0, s56, 131072
  s_nop 0
  buffer_load_dwordx4 v2, s[12:15], s92 offen offset:0 lds
  buffer_load_dwordx4 v3, s[12:15], s92 offen offset:1024 lds
  buffer_load_dwordx4 v4, s[12:15], s92 offen offset:2048 lds
  buffer_load_dwordx4 v5, s[12:15], s92 offen offset:3072 lds
  v_lshrrev_b32 v224, 8, v0
  v_bfe_u32 v225, v0, 2, 6
  v_and_b32 v226, 3, v0
  v_lshrrev_b32 v227, 5, v225
  v_and_b32 v228, 31, v225
  v_lshlrev_b32 v229, 3, v224
  v_lshl_add_u32 v229, v226, 1, v229
  v_lshrrev_b32 v230, 2, v229
  v_lshl_add_u32 v230, v230, 1, v227
  v_and_b32 v231, 3, v229
  v_lshl_add_u32 v231, v230, 2, v231
  v_lshrrev_b32 v232, 3, v228
  v_and_b32 v233, 3, v228
  v_lshl_add_u32 v232, v232, 2, v233
  v_bfe_u32 v233, v228, 2, 1
  v_subrev_u32 v234, 14, v232
  v_cmp_gt_u32 vcc, 14, v232
  v_mul_u32_u24 v233, 14, v233
  v_nop
  v_cndmask_b32 v232, v234, v232, vcc
  v_add_u32 v232, v232, v233
  v_mul_u32_u24 v231, 56, v231
  v_lshl_add_u32 v231, v232, 1, v231
  v_mov_b32 v232, 1600
  v_cmp_eq_u32 vcc, 7, v230
  v_lshlrev_b32 v235, 2, v0
  v_nop
  v_cndmask_b32 v231, v231, v232, vcc
  v_and_b32 v208, 31, v1
  v_lshrrev_b32 v209, 5, v1
  v_and_b32 v18, 7, v208
  v_lshlrev_b32 v210, 1, v209
  v_xor_b32 v18, v18, v210
  v_lshlrev_b32 v18, 4, v18
  v_lshl_add_u32 v18, v208, 7, v18
  s_add_u32 s34, s56, 131072
  v_add_u32 v18, s34, v18
  v_bfe_u32 v19, v208, 1, 2
  v_xor_b32 v19, v19, v210
  v_lshlrev_b32 v19, 4, v19
  v_lshl_add_u32 v19, v208, 6, v19
  s_add_u32 s34, s56, 65536
  v_add_u32 v19, s34, v19
  v_lshrrev_b32 v211, 4, v1
  v_bfe_u32 v212, v1, 2, 2
  v_and_b32 v213, 3, v1
  v_and_b32 v214, 1, v211
  v_lshrrev_b32 v215, 1, v211
  v_lshlrev_b32 v216, 4, v215
  v_lshl_add_u32 v216, v214, 2, v216
  v_add_u32 v216, v216, v212
  v_lshrrev_b32 v217, 1, v213
  v_and_b32 v218, 1, v213
  s_lshr_b32 s34, s31, 1
  s_lshl_b32 s34, s34, 1
  v_add_u32 v20, s34, v217
  v_and_b32 v21, 7, v216
  v_xor_b32 v20, v20, v21
  v_lshlrev_b32 v20, 4, v20
  v_lshl_add_u32 v20, v216, 7, v20
  s_waitcnt vmcnt(9) lgkmcnt(0)
  s_barrier
  s_cmp_lt_u32 s31, 4
  s_cbranch_scc0 L_o_3
  s_add_u32 m0, s56, 32768
  s_nop 0
  buffer_load_dwordx4 v2, s[12:15], s93 offen offset:0 lds
  buffer_load_dwordx4 v3, s[12:15], s93 offen offset:1024 lds
  buffer_load_dwordx4 v4, s[12:15], s93 offen offset:2048 lds
  buffer_load_dwordx4 v5, s[12:15], s93 offen offset:3072 lds
L_o_3:
  ds_read_b128 v[32:35], v8 offset:32768
  ds_read_b64_tr_b16 v[176:177], v16 offset:0
  ds_read_b64_tr_b16 v[178:179], v16 offset:256
  ds_read_b128 v[36:39], v9 offset:32768
  ds_read_b64_tr_b16 v[180:181], v16 offset:1024
  ds_read_b64_tr_b16 v[182:183], v16 offset:1280
  ds_read_b128 v[40:43], v10 offset:32768
  ds_read_b64_tr_b16 v[184:185], v16 offset:2048
  ds_read_b64_tr_b16 v[186:187], v16 offset:2304
  ds_read_b128 v[44:47], v11 offset:32768
  ds_read_b64_tr_b16 v[188:189], v16 offset:3072
  ds_read_b64_tr_b16 v[190:191], v16 offset:3328
  s_waitcnt lgkmcnt(9)
  v_mfma_f32_32x32x16_bf16 v[144:159], v[176:179], v[32:35], v[144:159]
  v_lshl_add_u32 v20, v218, 3, v20
  v_add_u32 v20, 131072, v20
  s_lshl_b32 s34, s57, 1
  v_add_u32 v21, s34, v217
  v_bfe_u32 v219, v216, 1, 2
  s_waitcnt lgkmcnt(6)
  v_mfma_f32_32x32x16_bf16 v[144:159], v[180:183], v[36:39], v[144:159]
  v_xor_b32 v21, v21, v219
  v_lshlrev_b32 v21, 4, v21
  v_lshl_add_u32 v21, v216, 6, v21
  v_lshl_add_u32 v21, v218, 3, v21
  v_add_u32 v21, 65536, v21
  s_waitcnt lgkmcnt(3)
  v_mfma_f32_32x32x16_bf16 v[144:159], v[184:187], v[40:43], v[144:159]
  v_lshl_add_u32 v219, v214, 1, v217
  v_lshrrev_b32 v220, 1, v212
  v_lshlrev_b32 v220, 2, v220
  v_xor_b32 v219, v219, v220
  v_lshlrev_b32 v219, 4, v219
  s_waitcnt lgkmcnt(0)
  v_mfma_f32_32x32x16_bf16 v[144:159], v[188:191], v[44:47], v[144:159]
  v_lshl_add_u32 v219, v218, 3, v219
  v_lshl_add_u32 v219, v212, 7, v219
  v_lshl_add_u32 v219, v215, 10, v219
  s_lshl_b32 s34, s58, 4
  s_lshl_b32 s35, s59, 3
  s_cmp_lt_u32 s31, 4
  s_cbranch_scc1 L_o_4
  s_mul_i32 s32, s93, 1344
  s_add_u32 m0, s67, 12288
  s_add_u32 s32, s32, 896
  buffer_load_dwordx4 v6, s[16:19], s32 offen lds
  s_add_u32 m0, s56, 32768
  s_nop 0
  buffer_load_dwordx4 v2, s[12:15], s93 offen offset:0 lds
  buffer_load_dwordx4 v3, s[12:15], s93 offen offset:1024 lds
  buffer_load_dwordx4 v4, s[12:15], s93 offen offset:2048 lds
  buffer_load_dwordx4 v5, s[12:15], s93 offen offset:3072 lds
L_o_4:
  s_waitcnt vmcnt(9) lgkmcnt(0)
  s_barrier
  s_cmp_lt_u32 s31, 4
  s_cbranch_scc0 L_o_5
  s_mul_i32 s32, s94, 1344
  s_add_u32 m0, s67, 16384
  s_add_u32 s32, s32, 896
  buffer_load_dwordx4 v6, s[16:19], s32 offen lds
  s_add_u32 m0, s56, 65536
  s_nop 0
  buffer_load_dwordx4 v2, s[12:15], s94 offen offset:0 lds
  buffer_load_dwordx4 v3, s[12:15], s94 offen offset:1024 lds
  buffer_load_dwordx4 v4, s[12:15], s94 offen offset:2048 lds
  buffer_load_dwordx4 v5, s[12:15], s94 offen offset:3072 lds
L_o_5:
  ds_read_b128 v[48:51], v12 offset:0
  ds_read_b64_tr_b16 v[176:177], v16 offset:4096
  ds_read_b64_tr_b16 v[178:179], v16 offset:4352
  ds_read_b128 v[52:55], v13 offset:0
  ds_read_b64_tr_b16 v[180:181], v16 offset:5120
  ds_read_b64_tr_b16 v[182:183], v16 offset:5376
  ds_read_b128 v[56:59], v14 offset:0
  ds_read_b64_tr_b16 v[184:185], v16 offset:6144
  ds_read_b64_tr_b16 v[186:187], v16 offset:6400
  ds_read_b128 v[60:63], v15 offset:0
  ds_read_b64_tr_b16 v[188:189], v16 offset:7168
  ds_read_b64_tr_b16 v[190:191], v16 offset:7424
  s_waitcnt lgkmcnt(9)
  v_mfma_f32_32x32x16_bf16 v[144:159], v[176:179], v[48:51], v[144:159]
  s_add_u32 s34, s34, s35
  s_lshl_b32 s34, s34, 12
  s_add_u32 s34, s34, 32768
  v_add_u32 v25, s34, v219
  s_lshl_b32 s34, s58, 6
  s_waitcnt lgkmcnt(6)
  v_mfma_f32_32x32x16_bf16 v[144:159], v[180:183], v[52:55], v[144:159]
  s_lshl_b32 s35, s59, 5
  s_or_b32 s34, s34, s35
  v_xor_b32 v25, s34, v25
  v_xor_b32 v26, 64, v25
  v_and_b32 v219, 15, v1
  s_waitcnt lgkmcnt(3)
  v_mfma_f32_32x32x16_bf16 v[144:159], v[184:187], v[56:59], v[144:159]
  v_lshrrev_b32 v220, 2, v219
  v_lshlrev_b32 v220, 3, v220
  v_and_b32 v221, 3, v219
  s_lshl_b32 s35, s57, 2
  v_add3_u32 v220, v220, v221, s35
  s_waitcnt lgkmcnt(0)
  v_mfma_f32_32x32x16_bf16 v[144:159], v[188:191], v[60:63], v[144:159]
  v_subrev_u32 v221, 14, v220
  v_cmp_le_u32 vcc, 14, v220
  v_mov_b32 v222, 0
  v_mov_b32 v223, 4
  v_cndmask_b32 v221, v220, v221, vcc
  s_cmp_lt_u32 s31, 4
  s_cbranch_scc1 L_o_6
  s_add_u32 m0, s56, 65536
  s_nop 0
  buffer_load_dwordx4 v2, s[12:15], s94 offen offset:0 lds
  buffer_load_dwordx4 v3, s[12:15], s94 offen offset:1024 lds
  buffer_load_dwordx4 v4, s[12:15], s94 offen offset:2048 lds
  buffer_load_dwordx4 v5, s[12:15], s94 offen offset:3072 lds
L_o_6:
  s_waitcnt vmcnt(9) lgkmcnt(0)
  s_barrier
  s_cmp_lt_u32 s31, 4
  s_cbranch_scc0 L_o_7
  s_add_u32 m0, s56, 98304
  s_nop 0
  buffer_load_dwordx4 v2, s[12:15], s95 offen offset:0 lds
  buffer_load_dwordx4 v3, s[12:15], s95 offen offset:1024 lds
  buffer_load_dwordx4 v4, s[12:15], s95 offen offset:2048 lds
  buffer_load_dwordx4 v5, s[12:15], s95 offen offset:3072 lds
L_o_7:
  ds_read_b128 v[64:67], v12 offset:32768
  ds_read_b64_tr_b16 v[176:177], v16 offset:8192
  ds_read_b64_tr_b16 v[178:179], v16 offset:8448
  ds_read_b128 v[68:71], v13 offset:32768
  ds_read_b64_tr_b16 v[180:181], v16 offset:9216
  ds_read_b64_tr_b16 v[182:183], v16 offset:9472
  ds_read_b128 v[72:75], v14 offset:32768
  ds_read_b64_tr_b16 v[184:185], v16 offset:10240
  ds_read_b64_tr_b16 v[186:187], v16 offset:10496
  ds_read_b128 v[76:79], v15 offset:32768
  ds_read_b64_tr_b16 v[188:189], v16 offset:11264
  ds_read_b64_tr_b16 v[190:191], v16 offset:11520
  s_waitcnt lgkmcnt(9)
  v_mfma_f32_32x32x16_bf16 v[144:159], v[176:179], v[64:67], v[144:159]
  v_cndmask_b32 v222, v222, v223, vcc
  v_lshrrev_b32 v223, 2, v221
  v_lshl_add_u32 v222, v223, 3, v222
  v_and_b32 v221, 3, v221
  v_add_u32 v222, v222, v221
  s_waitcnt lgkmcnt(6)
  v_mfma_f32_32x32x16_bf16 v[144:159], v[180:183], v[68:71], v[144:159]
  v_subrev_u32 v221, 12, v219
  v_and_b32 v223, 1, v221
  v_lshlrev_b32 v223, 2, v223
  v_lshrrev_b32 v221, 1, v221
  v_add3_u32 v223, v223, v221, 26
  s_waitcnt lgkmcnt(3)
  v_mfma_f32_32x32x16_bf16 v[144:159], v[184:187], v[72:75], v[144:159]
  v_cmp_le_u32 vcc, 28, v220
  v_cmp_le_u32 s[64:65], 30, v220
  v_nop
  v_cndmask_b32 v222, v222, v223, vcc
  s_lshl_b32 s34, s59, 11
  s_waitcnt lgkmcnt(0)
  v_mfma_f32_32x32x16_bf16 v[144:159], v[188:191], v[76:79], v[144:159]
  s_lshl_b32 s35, s58, 9
  s_add_u32 s34, s34, s35
  s_add_u32 s34, s34, 0
  v_lshlrev_b32 v221, 10, v215
  v_lshl_add_u32 v221, v222, 4, v221
  s_cmp_lt_u32 s31, 4
  s_cbranch_scc1 L_o_8
  s_mul_i32 s32, s95, 1344
  s_add_u32 m0, s67, 20480
  s_add_u32 s32, s32, 896
  buffer_load_dwordx4 v6, s[16:19], s32 offen lds
  s_add_u32 m0, s56, 98304
  s_nop 0
  buffer_load_dwordx4 v2, s[12:15], s95 offen offset:0 lds
  buffer_load_dwordx4 v3, s[12:15], s95 offen offset:1024 lds
  buffer_load_dwordx4 v4, s[12:15], s95 offen offset:2048 lds
  buffer_load_dwordx4 v5, s[12:15], s95 offen offset:3072 lds
L_o_8:
  s_waitcnt vmcnt(9) lgkmcnt(0)
  s_barrier
  s_cmp_lt_u32 s31, 4
  s_cbranch_scc0 L_o_9
  s_mul_i32 s32, s96, 1344
  s_add_u32 m0, s67, 24576
  s_add_u32 s32, s32, 896
  buffer_load_dwordx4 v6, s[16:19], s32 offen lds
  s_add_u32 m0, s56, 131072
  s_nop 0
  buffer_load_dwordx4 v2, s[12:15], s96 offen offset:0 lds
  buffer_load_dwordx4 v3, s[12:15], s96 offen offset:1024 lds
  buffer_load_dwordx4 v4, s[12:15], s96 offen offset:2048 lds
  buffer_load_dwordx4 v5, s[12:15], s96 offen offset:3072 lds
L_o_9:
  ds_read_b128 v[80:83], v8 offset:0
  ds_read_b64_tr_b16 v[176:177], v16 offset:12288
  ds_read_b64_tr_b16 v[178:179], v16 offset:12544
  ds_read_b128 v[84:87], v9 offset:0
  ds_read_b64_tr_b16 v[180:181], v16 offset:13312
  ds_read_b64_tr_b16 v[182:183], v16 offset:13568
  ds_read_b128 v[88:91], v10 offset:0
  ds_read_b64_tr_b16 v[184:185], v16 offset:14336
  ds_read_b64_tr_b16 v[186:187], v16 offset:14592
  ds_read_b128 v[92:95], v11 offset:0
  ds_read_b64_tr_b16 v[188:189], v16 offset:15360
  ds_read_b64_tr_b16 v[190:191], v16 offset:15616
  s_waitcnt lgkmcnt(9)
  v_mfma_f32_32x32x16_bf16 v[144:159], v[176:179], v[80:83], v[144:159]
  v_lshl_add_u32 v221, v214, 3, v221
  v_add_u32 v22, s34, v221
  v_mov_b32 v23, 0x3f803f80
  v_cmp_eq_u32 vcc, 3, v211
  v_mov_b32 v221, 0
  s_waitcnt lgkmcnt(6)
  v_mfma_f32_32x32x16_bf16 v[144:159], v[180:183], v[84:87], v[144:159]
  v_nop
  v_cndmask_b32 v23, v23, v221, vcc
  v_lshrrev_b32 v219, 3, v1
  v_and_b32 v220, 7, v1
  v_bfe_u32 v221, v219, 1, 1
  s_waitcnt lgkmcnt(3)
  v_mfma_f32_32x32x16_bf16 v[144:159], v[184:187], v[88:91], v[144:159]
  v_lshlrev_b32 v221, 2, v221
  v_xor_b32 v220, v220, v221
  v_mul_u32_u24 v24, 896, v219
  v_lshl_add_u32 v24, v220, 4, v24
  s_lshl_b32 s34, s52, 7
  s_waitcnt lgkmcnt(0)
  v_mfma_f32_32x32x16_bf16 v[144:159], v[188:191], v[92:95], v[144:159]
  v_add_u32 v24, s34, v24
  v_cmp_eq_u32 vcc, 7, v219
  v_mov_b32 v220, 0x40000000
  v_nop
  v_cndmask_b32 v24, v24, v220, vcc
  s_cmp_lt_u32 s31, 4
  s_cbranch_scc1 L_o_10
  s_add_u32 m0, s56, 131072
  s_nop 0
  buffer_load_dwordx4 v2, s[12:15], s96 offen offset:0 lds
  buffer_load_dwordx4 v3, s[12:15], s96 offen offset:1024 lds
  buffer_load_dwordx4 v4, s[12:15], s96 offen offset:2048 lds
  buffer_load_dwordx4 v5, s[12:15], s96 offen offset:3072 lds
L_o_10:
  s_waitcnt vmcnt(9) lgkmcnt(0)
  s_barrier
  s_cmp_lt_u32 s31, 4
  s_cbranch_scc0 L_o_11
  s_mul_i32 s32, s90, 1344
  s_add_u32 m0, s67, 32768
  s_add_u32 s32, s32, 1792
  buffer_load_dwordx4 v6, s[16:19], s32 offen lds
  s_mul_i32 s32, s92, 1344
  s_add_u32 m0, s67, 40960
  s_add_u32 s32, s32, 1792
  buffer_load_dwordx4 v6, s[16:19], s32 offen lds
L_o_11:
  ds_read_b128 v[96:99], v8 offset:32768
  ds_read_b64_tr_b16 v[176:177], v16 offset:16384
  ds_read_b64_tr_b16 v[178:179], v16 offset:16640
  ds_read_b128 v[100:103], v9 offset:32768
  ds_read_b64_tr_b16 v[180:181], v16 offset:17408
  ds_read_b64_tr_b16 v[182:183], v16 offset:17664
  ds_read_b128 v[104:107], v10 offset:32768
  ds_read_b64_tr_b16 v[184:185], v16 offset:18432
  ds_read_b64_tr_b16 v[186:187], v16 offset:18688
  ds_read_b128 v[108:111], v11 offset:32768
  ds_read_b64_tr_b16 v[188:189], v16 offset:19456
  ds_read_b64_tr_b16 v[190:191], v16 offset:19712
  s_waitcnt lgkmcnt(9)
  v_mfma_f32_32x32x16_bf16 v[144:159], v[176:179], v[96:99], v[144:159]
  s_lshl_b32 s34, s53, 6
  s_lshl_b32 s35, s57, 5
  s_add_u32 s34, s34, s35
  v_add_u32 v28, s34, v208
  v_mul_u32_u24 v29, 896, v28
  s_waitcnt lgkmcnt(6)
  v_mfma_f32_32x32x16_bf16 v[144:159], v[180:183], v[100:103], v[144:159]
  v_lshlrev_b32 v28, 3, v28
  v_add_u32 v28, 3145728, v28
  s_lshl_b32 s34, s58, 1
  s_add_u32 s34, s34, s59
  s_lshl_b32 s34, s34, 5
  s_waitcnt lgkmcnt(3)
  v_mfma_f32_32x32x16_bf16 v[144:159], v[184:187], v[104:107], v[144:159]
  s_lshl_b32 s35, s52, 7
  s_add_u32 s34, s34, s35
  v_lshl_add_u32 v29, v209, 4, v29
  v_add_u32 v29, s34, v29
  s_lshl_b32 s34, s59, 3
  s_add_u32 s34, s34, s52
  s_mov_b32 s3, 0x64275310
  s_cmp_eq_u32 s34, 1
  s_cselect_b32 s3, 0x26407531, s3
  s_cmp_eq_u32 s34, 2
  s_cselect_b32 s3, 0x42610753, s3
  s_cmp_eq_u32 s34, 3
  s_cselect_b32 s3, 0x64231075, s3
  s_cmp_eq_u32 s34, 4
  s_cselect_b32 s3, 0x26453107, s3
  s_cmp_eq_u32 s34, 5
  s_cselect_b32 s3, 0x42675310, s3
  s_cmp_eq_u32 s34, 6
  s_cselect_b32 s3, 0x64207531, s3
  s_cmp_eq_u32 s34, 7
  s_cselect_b32 s3, 0x26410753, s3
  s_cmp_eq_u32 s34, 8
  s_cselect_b32 s3, 0x53176420, s3
  s_cmp_eq_u32 s34, 9
  s_cselect_b32 s3, 0x15307642, s3
  s_cmp_eq_u32 s34, 10
  s_cselect_b32 s3, 0x31520764, s3
  s_cmp_eq_u32 s34, 11
  s_cselect_b32 s3, 0x53142076, s3
  s_cmp_eq_u32 s34, 12
  s_cselect_b32 s3, 0x15364207, s3
  s_cmp_eq_u32 s34, 13
  s_cselect_b32 s3, 0x31576420, s3
  s_cmp_eq_u32 s34, 14
  s_cselect_b32 s3, 0x53107642, s3
  s_cmp_eq_u32 s34, 15
  s_cselect_b32 s3, 0x15320764, s3
  s_mov_b32 s38, 10836
  s_lshr_b32 s38, s38, s29
  s_and_b32 s38, s38, 1
  s_waitcnt lgkmcnt(0)
  v_mfma_f32_32x32x16_bf16 v[144:159], v[188:191], v[108:111], v[144:159]
  ds_read_u16 v233, v231 offset:28672
  ds_read_u16 v234, v231 offset:28728
  s_waitcnt lgkmcnt(0)
  v_lshl_or_b32 v233, v234, 16, v233
  ds_write_b32 v235, v233 offset:30720
  s_cmp_lt_u32 s31, 4
  s_cbranch_scc1 L_o_12
  s_mul_i32 s32, s91, 1344
  s_add_u32 m0, s67, 36864
  s_add_u32 s32, s32, 1792
  buffer_load_dwordx4 v6, s[16:19], s32 offen lds
  s_mul_i32 s32, s93, 1344
  s_add_u32 m0, s67, 45056
  s_add_u32 s32, s32, 1792
  buffer_load_dwordx4 v6, s[16:19], s32 offen lds
L_o_12:
  s_waitcnt vmcnt(6) lgkmcnt(0)
  s_barrier
  s_cmp_lt_u32 s31, 4
  s_cbranch_scc0 L_o_13
  s_mul_i32 s32, s94, 1344
  s_add_u32 m0, s67, 49152
  s_add_u32 s32, s32, 1792
  buffer_load_dwordx4 v6, s[16:19], s32 offen lds
  s_mul_i32 s32, s96, 1344
  s_add_u32 m0, s67, 57344
  s_add_u32 s32, s32, 1792
  buffer_load_dwordx4 v6, s[16:19], s32 offen lds
L_o_13:
  ds_read_b128 v[112:115], v12 offset:0
  ds_read_b64_tr_b16 v[176:177], v16 offset:20480
  ds_read_b64_tr_b16 v[178:179], v16 offset:20736
  ds_read_b128 v[116:119], v13 offset:0
  ds_read_b64_tr_b16 v[180:181], v16 offset:21504
  ds_read_b64_tr_b16 v[182:183], v16 offset:21760
  ds_read_b128 v[120:123], v14 offset:0
  ds_read_b64_tr_b16 v[184:185], v16 offset:22528
  ds_read_b64_tr_b16 v[186:187], v16 offset:22784
  ds_read_b128 v[124:127], v15 offset:0
  ds_read_b64_tr_b16 v[188:189], v16 offset:23552
  ds_read_b64_tr_b16 v[190:191], v16 offset:23808
  s_waitcnt lgkmcnt(9)
  v_mfma_f32_32x32x16_bf16 v[144:159], v[176:179], v[112:115], v[144:159]
  s_waitcnt lgkmcnt(6)
  v_mfma_f32_32x32x16_bf16 v[144:159], v[180:183], v[116:119], v[144:159]
  s_waitcnt lgkmcnt(3)
  v_mfma_f32_32x32x16_bf16 v[144:159], v[184:187], v[120:123], v[144:159]
  s_waitcnt lgkmcnt(0)
  v_mfma_f32_32x32x16_bf16 v[144:159], v[188:191], v[124:127], v[144:159]
  s_cmp_lt_u32 s31, 4
  s_cbranch_scc1 L_o_14
  s_mul_i32 s32, s95, 1344
  s_add_u32 m0, s67, 53248
  s_add_u32 s32, s32, 1792
  buffer_load_dwordx4 v6, s[16:19], s32 offen lds
L_o_14:
  s_waitcnt vmcnt(3) lgkmcnt(0)
  s_barrier
  ds_read_b128 v[128:131], v12 offset:32768
  ds_read_b64_tr_b16 v[176:177], v16 offset:24576
  ds_read_b64_tr_b16 v[178:179], v16 offset:24832
  ds_read_b128 v[132:135], v13 offset:32768
  ds_read_b64_tr_b16 v[180:181], v16 offset:25600
  ds_read_b64_tr_b16 v[182:183], v16 offset:25856
  ds_read_b128 v[136:139], v14 offset:32768
  ds_read_b64_tr_b16 v[184:185], v16 offset:26624
  ds_read_b64_tr_b16 v[186:187], v16 offset:26880
  ds_read_b128 v[140:143], v15 offset:32768
  ds_read_b64_tr_b16 v[188:189], v16 offset:27648
  ds_read_b64_tr_b16 v[190:191], v16 offset:27904
  ds_read_b128 v[216:219], v7 offset:30720
  ds_read_b128 v[220:223], v7 offset:31744
  s_waitcnt lgkmcnt(11)
  v_mfma_f32_32x32x16_bf16 v[144:159], v[176:179], v[128:131], v[144:159]
  s_waitcnt lgkmcnt(8)
  v_mfma_f32_32x32x16_bf16 v[144:159], v[180:183], v[132:135], v[144:159]
  s_waitcnt lgkmcnt(5)
  v_mfma_f32_32x32x16_bf16 v[144:159], v[184:187], v[136:139], v[144:159]
  s_waitcnt lgkmcnt(2)
  v_mfma_f32_32x32x16_bf16 v[144:159], v[188:191], v[140:143], v[144:159]
  s_nop 11
  v_cvt_pk_bf16_f32 v208, v144, v145
  v_cvt_pk_bf16_f32 v209, v146, v147
  v_cvt_pk_bf16_f32 v210, v148, v149
  v_cvt_pk_bf16_f32 v211, v150, v151
  v_cvt_pk_bf16_f32 v212, v152, v153
  v_cvt_pk_bf16_f32 v213, v154, v155
  v_cvt_pk_bf16_f32 v214, v156, v157
  v_cvt_pk_bf16_f32 v215, v158, v159
  s_waitcnt lgkmcnt(0)
  v_mfma_f32_32x32x16_bf16 v[144:159], v[216:219], v[208:211], 0
  v_mfma_f32_32x32x16_bf16 v[144:159], v[220:223], v[212:215], v[144:159]
  s_nop 13
  v_max3_f32 v240, v144, v145, v146
  v_min3_f32 v242, v144, v145, v146
  v_max3_f32 v244, v147, v148, v149
  v_min3_f32 v245, v147, v148, v149
  v_max3_f32 v240, v240, v150, v151
  v_min3_f32 v242, v242, v150, v151
  v_max3_f32 v244, v244, v152, v153
  v_min3_f32 v245, v245, v152, v153
  v_max3_f32 v240, v240, v154, v155
  v_min3_f32 v242, v242, v154, v155
  v_max3_f32 v244, v244, v156, v157
  v_min3_f32 v245, v245, v156, v157
  v_max_f32 v240, v240, v244
  v_min_f32 v242, v242, v245
  v_mov_b32 v244, v240
  v_mov_b32 v245, v242
  s_nop 1
  v_permlane32_swap_b32 v240, v244
  v_permlane32_swap_b32 v242, v245
  v_max_f32 v240, v240, v244
  v_min_f32 v242, v242, v245
  v_mul_f32 v240, s50, v240
  v_mul_f32 v242, s50, v242
  v_pk_fma_f32 v[224:225], v[144:145], s[50:51], v[240:241] op_sel_hi:[1,0,0] neg_lo:[0,0,1] neg_hi:[0,0,1]
  v_pk_fma_f32 v[144:145], v[144:145], s[50:51], v[242:243] op_sel_hi:[1,0,0] neg_lo:[1,0,0] neg_hi:[1,0,0]
  v_pk_fma_f32 v[226:227], v[146:147], s[50:51], v[240:241] op_sel_hi:[1,0,0] neg_lo:[0,0,1] neg_hi:[0,0,1]
  v_pk_fma_f32 v[146:147], v[146:147], s[50:51], v[242:243] op_sel_hi:[1,0,0] neg_lo:[1,0,0] neg_hi:[1,0,0]
  v_pk_fma_f32 v[228:229], v[148:149], s[50:51], v[240:241] op_sel_hi:[1,0,0] neg_lo:[0,0,1] neg_hi:[0,0,1]
  v_pk_fma_f32 v[148:149], v[148:149], s[50:51], v[242:243] op_sel_hi:[1,0,0] neg_lo:[1,0,0] neg_hi:[1,0,0]
  v_pk_fma_f32 v[230:231], v[150:151], s[50:51], v[240:241] op_sel_hi:[1,0,0] neg_lo:[0,0,1] neg_hi:[0,0,1]
  v_pk_fma_f32 v[150:151], v[150:151], s[50:51], v[242:243] op_sel_hi:[1,0,0] neg_lo:[1,0,0] neg_hi:[1,0,0]
  v_pk_fma_f32 v[232:233], v[152:153], s[50:51], v[240:241] op_sel_hi:[1,0,0] neg_lo:[0,0,1] neg_hi:[0,0,1]
  v_pk_fma_f32 v[152:153], v[152:153], s[50:51], v[242:243] op_sel_hi:[1,0,0] neg_lo:[1,0,0] neg_hi:[1,0,0]
  v_pk_fma_f32 v[234:235], v[154:155], s[50:51], v[240:241] op_sel_hi:[1,0,0] neg_lo:[0,0,1] neg_hi:[0,0,1]
  v_pk_fma_f32 v[154:155], v[154:155], s[50:51], v[242:243] op_sel_hi:[1,0,0] neg_lo:[1,0,0] neg_hi:[1,0,0]
  v_pk_fma_f32 v[236:237], v[156:157], s[50:51], v[240:241] op_sel_hi:[1,0,0] neg_lo:[0,0,1] neg_hi:[0,0,1]
  v_pk_fma_f32 v[156:157], v[156:157], s[50:51], v[242:243] op_sel_hi:[1,0,0] neg_lo:[1,0,0] neg_hi:[1,0,0]
  v_exp_f32 v224, v224
  v_exp_f32 v144, v144
  v_exp_f32 v225, v225
  v_exp_f32 v145, v145
  v_exp_f32 v226, v226
  v_exp_f32 v146, v146
  v_exp_f32 v227, v227
  v_exp_f32 v147, v147
  v_exp_f32 v228, v228
  v_exp_f32 v148, v148
  v_exp_f32 v229, v229
  v_exp_f32 v149, v149
  v_exp_f32 v230, v230
  v_exp_f32 v150, v150
  v_exp_f32 v231, v231
  v_exp_f32 v151, v151
  v_exp_f32 v232, v232
  v_exp_f32 v152, v152
  v_exp_f32 v233, v233
  v_exp_f32 v153, v153
  v_exp_f32 v234, v234
  v_exp_f32 v154, v154
  v_exp_f32 v235, v235
  v_exp_f32 v155, v155
  v_exp_f32 v236, v236
  v_exp_f32 v156, v156
  v_exp_f32 v237, v237
  v_exp_f32 v157, v157
  s_waitcnt vmcnt(0)
  s_barrier
  s_cmp_lt_u32 s31, 4
  s_cbranch_scc0 L_sB_15
  ds_read_b64_tr_b16 v[176:177], v16 offset:32768
  ds_read_b64_tr_b16 v[178:179], v16 offset:33024
  ds_read_b64_tr_b16 v[180:181], v16 offset:33792
  ds_read_b64_tr_b16 v[182:183], v16 offset:34048
  ds_read_b64_tr_b16 v[184:185], v16 offset:34816
  ds_read_b64_tr_b16 v[186:187], v16 offset:35072
  ds_read_b64_tr_b16 v[188:189], v16 offset:35840
  ds_read_b64_tr_b16 v[190:191], v16 offset:36096
  ds_read_b64_tr_b16 v[192:193], v16 offset:36864
  ds_read_b64_tr_b16 v[194:195], v16 offset:37120
  ds_read_b64_tr_b16 v[196:197], v16 offset:37888
  ds_read_b64_tr_b16 v[198:199], v16 offset:38144
  ds_read_b64_tr_b16 v[200:201], v16 offset:38912
  ds_read_b64_tr_b16 v[202:203], v16 offset:39168
  s_waitcnt lgkmcnt(12)
  v_mfma_f32_32x32x16_bf16 v[160:175], v[176:179], v[32:35], v[160:175]
  ds_read_b64_tr_b16 v[204:205], v16 offset:39936
  ds_read_b64_tr_b16 v[206:207], v16 offset:40192
  s_waitcnt lgkmcnt(12)
  v_mfma_f32_32x32x16_bf16 v[160:175], v[180:183], v[36:39], v[160:175]
  ds_read_b64_tr_b16 v[176:177], v16 offset:40960
  ds_read_b64_tr_b16 v[178:179], v16 offset:41216
  s_waitcnt lgkmcnt(12)
  v_mfma_f32_32x32x16_bf16 v[160:175], v[184:187], v[40:43], v[160:175]
  ds_read_b64_tr_b16 v[180:181], v16 offset:41984
  ds_read_b64_tr_b16 v[182:183], v16 offset:42240
  s_waitcnt lgkmcnt(12)
  v_mfma_f32_32x32x16_bf16 v[160:175], v[188:191], v[44:47], v[160:175]
  ds_read_b64_tr_b16 v[184:185], v16 offset:43008
  ds_read_b64_tr_b16 v[186:187], v16 offset:43264
  s_mul_i32 s32, s90, 1344
  s_add_u32 m0, s67, 0
  s_nop 0
  buffer_load_dwordx4 v6, s[16:19], s32 offen lds
  s_waitcnt lgkmcnt(12)
  v_mfma_f32_32x32x16_bf16 v[160:175], v[192:195], v[48:51], v[160:175]
  ds_read_b64_tr_b16 v[188:189], v16 offset:44032
  ds_read_b64_tr_b16 v[190:191], v16 offset:44288
  s_waitcnt lgkmcnt(12)
  v_mfma_f32_32x32x16_bf16 v[160:175], v[196:199], v[52:55], v[160:175]
  ds_read_b64_tr_b16 v[192:193], v16 offset:45056
  ds_read_b64_tr_b16 v[194:195], v16 offset:45312
  s_waitcnt lgkmcnt(12)
  v_mfma_f32_32x32x16_bf16 v[160:175], v[200:203], v[56:59], v[160:175]
  ds_read_b64_tr_b16 v[196:197], v16 offset:46080
  ds_read_b64_tr_b16 v[198:199], v16 offset:46336
  s_waitcnt lgkmcnt(12)
  v_mfma_f32_32x32x16_bf16 v[160:175], v[204:207], v[60:63], v[160:175]
  ds_read_b64_tr_b16 v[200:201], v16 offset:47104
  ds_read_b64_tr_b16 v[202:203], v16 offset:47360
  s_waitcnt lgkmcnt(12)
  v_mfma_f32_32x32x16_bf16 v[160:175], v[176:179], v[64:67], v[160:175]
  ds_read_b64_tr_b16 v[204:205], v16 offset:48128
  ds_read_b64_tr_b16 v[206:207], v16 offset:48384
  s_waitcnt lgkmcnt(12)
  v_mfma_f32_32x32x16_bf16 v[160:175], v[180:183], v[68:71], v[160:175]
  ds_read_b64_tr_b16 v[176:177], v16 offset:49152
  ds_read_b64_tr_b16 v[178:179], v16 offset:49408
  s_waitcnt lgkmcnt(12)
  v_mfma_f32_32x32x16_bf16 v[160:175], v[184:187], v[72:75], v[160:175]
  ds_read_b64_tr_b16 v[180:181], v16 offset:50176
  ds_read_b64_tr_b16 v[182:183], v16 offset:50432
  s_mul_i32 s32, s92, 1344
  s_add_u32 m0, s67, 8192
  s_nop 0
  buffer_load_dwordx4 v6, s[16:19], s32 offen lds
  s_waitcnt lgkmcnt(12)
  v_mfma_f32_32x32x16_bf16 v[160:175], v[188:191], v[76:79], v[160:175]
  ds_read_b64_tr_b16 v[184:185], v16 offset:51200
  ds_read_b64_tr_b16 v[186:187], v16 offset:51456
  s_waitcnt lgkmcnt(12)
  v_mfma_f32_32x32x16_bf16 v[160:175], v[192:195], v[80:83], v[160:175]
  ds_read_b64_tr_b16 v[188:189], v16 offset:52224
  ds_read_b64_tr_b16 v[190:191], v16 offset:52480
  s_waitcnt lgkmcnt(12)
  v_mfma_f32_32x32x16_bf16 v[160:175], v[196:199], v[84:87], v[160:175]
  ds_read_b64_tr_b16 v[192:193], v16 offset:53248
  ds_read_b64_tr_b16 v[194:195], v16 offset:53504
  s_waitcnt lgkmcnt(12)
  v_mfma_f32_32x32x16_bf16 v[160:175], v[200:203], v[88:91], v[160:175]
  ds_read_b64_tr_b16 v[196:197], v16 offset:54272
  ds_read_b64_tr_b16 v[198:199], v16 offset:54528
  s_waitcnt lgkmcnt(12)
  v_mfma_f32_32x32x16_bf16 v[160:175], v[204:207], v[92:95], v[160:175]
  ds_read_b64_tr_b16 v[200:201], v16 offset:55296
  ds_read_b64_tr_b16 v[202:203], v16 offset:55552
  s_waitcnt lgkmcnt(12)
  v_mfma_f32_32x32x16_bf16 v[160:175], v[176:179], v[96:99], v[160:175]
  ds_read_b64_tr_b16 v[204:205], v16 offset:56320
  ds_read_b64_tr_b16 v[206:207], v16 offset:56576
  s_waitcnt lgkmcnt(12)
  v_mfma_f32_32x32x16_bf16 v[160:175], v[180:183], v[100:103], v[160:175]
  ds_read_b64_tr_b16 v[176:177], v16 offset:57344
  ds_read_b64_tr_b16 v[178:179], v16 offset:57600
  s_mul_i32 s32, s94, 1344
  s_add_u32 m0, s67, 16384
  s_nop 0
  buffer_load_dwordx4 v6, s[16:19], s32 offen lds
  s_waitcnt lgkmcnt(12)
  v_mfma_f32_32x32x16_bf16 v[160:175], v[184:187], v[104:107], v[160:175]
  ds_read_b64_tr_b16 v[180:181], v16 offset:58368
  ds_read_b64_tr_b16 v[182:183], v16 offset:58624
  s_waitcnt lgkmcnt(12)
  v_mfma_f32_32x32x16_bf16 v[160:175], v[188:191], v[108:111], v[160:175]
  ds_read_b64_tr_b16 v[184:185], v16 offset:59392
  ds_read_b64_tr_b16 v[186:187], v16 offset:59648
  s_waitcnt lgkmcnt(12)
  v_mfma_f32_32x32x16_bf16 v[160:175], v[192:195], v[112:115], v[160:175]
  ds_read_b64_tr_b16 v[188:189], v16 offset:60416
  ds_read_b64_tr_b16 v[190:191], v16 offset:60672
  s_waitcnt lgkmcnt(12)
  v_mfma_f32_32x32x16_bf16 v[160:175], v[196:199], v[116:119], v[160:175]
  s_waitcnt lgkmcnt(10)
  v_mfma_f32_32x32x16_bf16 v[160:175], v[200:203], v[120:123], v[160:175]
  s_waitcnt lgkmcnt(8)
  v_mfma_f32_32x32x16_bf16 v[160:175], v[204:207], v[124:127], v[160:175]
  s_waitcnt lgkmcnt(6)
  v_mfma_f32_32x32x16_bf16 v[160:175], v[176:179], v[128:131], v[160:175]
  s_mul_i32 s32, s96, 1344
  s_add_u32 m0, s67, 24576
  s_nop 0
  buffer_load_dwordx4 v6, s[16:19], s32 offen lds
  s_waitcnt lgkmcnt(4)
  v_mfma_f32_32x32x16_bf16 v[160:175], v[180:183], v[132:135], v[160:175]
  s_waitcnt lgkmcnt(2)
  v_mfma_f32_32x32x16_bf16 v[160:175], v[184:187], v[136:139], v[160:175]
  s_waitcnt lgkmcnt(0)
  v_mfma_f32_32x32x16_bf16 v[160:175], v[188:191], v[140:143], v[160:175]
  v_add_f32 v240, v224, v225
  v_add_f32 v242, v144, v145
  v_add_f32 v241, v226, v227
  v_add_f32 v243, v146, v147
  v_add_f32 v240, v240, v228
  v_add_f32 v242, v242, v148
  v_add_f32 v241, v241, v229
  v_add_f32 v243, v243, v149
  v_add_f32 v240, v240, v230
  v_add_f32 v242, v242, v150
  v_add_f32 v241, v241, v231
  v_add_f32 v243, v243, v151
  v_add_f32 v240, v240, v232
  v_add_f32 v242, v242, v152
  v_add_f32 v241, v241, v233
  v_add_f32 v243, v243, v153
  v_add_f32 v240, v240, v234
  v_add_f32 v242, v242, v154
  v_add_f32 v241, v241, v235
  v_add_f32 v243, v243, v155
  v_add_f32 v240, v240, v236
  v_add_f32 v242, v242, v156
  v_add_f32 v241, v241, v237
  v_add_f32 v243, v243, v157
  v_add_f32 v240, v240, v241
  v_add_f32 v242, v242, v243
  v_mov_b32 v244, v240
  v_mov_b32 v245, v242
  s_nop 1
  v_permlane32_swap_b32 v240, v244
  v_permlane32_swap_b32 v242, v245
  v_add_f32 v240, v240, v244
  v_add_f32 v242, v242, v245
  v_rcp_f32 v240, v240
  v_rcp_f32 v242, v242
  s_nop 0
  v_mul_f32 v224, v224, v240
  v_mul_f32 v144, v144, v242
  v_mul_f32 v225, v225, v240
  v_mul_f32 v145, v145, v242
  v_mul_f32 v226, v226, v240
  v_mul_f32 v146, v146, v242
  v_mul_f32 v227, v227, v240
  v_mul_f32 v147, v147, v242
  v_mul_f32 v228, v228, v240
  v_mul_f32 v148, v148, v242
  v_mul_f32 v229, v229, v240
  v_mul_f32 v149, v149, v242
  v_mul_f32 v230, v230, v240
  v_mul_f32 v150, v150, v242
  v_mul_f32 v231, v231, v240
  v_mul_f32 v151, v151, v242
  v_mul_f32 v232, v232, v240
  v_mul_f32 v152, v152, v242
  v_mul_f32 v233, v233, v240
  v_mul_f32 v153, v153, v242
  v_mul_f32 v234, v234, v240
  v_mul_f32 v154, v154, v242
  v_mul_f32 v235, v235, v240
  v_mul_f32 v155, v155, v242
  v_mul_f32 v236, v236, v240
  v_mul_f32 v156, v156, v242
  v_mul_f32 v237, v237, v240
  v_mul_f32 v157, v157, v242
  v_cvt_pk_bf16_f32 v208, v224, v225
  v_cvt_pk_bf16_f32 v216, v144, v145
  v_cvt_pk_bf16_f32 v209, v226, v227
  v_cvt_pk_bf16_f32 v217, v146, v147
  v_cvt_pk_bf16_f32 v210, v228, v229
  v_cvt_pk_bf16_f32 v218, v148, v149
  v_cvt_pk_bf16_f32 v211, v230, v231
  v_cvt_pk_bf16_f32 v219, v150, v151
  v_cvt_pk_bf16_f32 v212, v232, v233
  v_cvt_pk_bf16_f32 v220, v152, v153
  v_cvt_pk_bf16_f32 v213, v234, v235
  v_cvt_pk_bf16_f32 v221, v154, v155
  v_cvt_pk_bf16_f32 v214, v236, v237
  v_cvt_pk_bf16_f32 v222, v156, v157
  v_mov_b32 v215, 0
  v_mov_b32 v223, 0
  v_xor_b32 v30, 16, v18
  v_xor_b32 v31, 64, v18
  ds_write_b128 v18, v[208:211]
  ds_write_b128 v30, v[212:215]
  v_xor_b32 v30, 80, v18
  ds_write_b128 v31, v[216:219]
  ds_write_b128 v30, v[220:223]
  s_branch L_sJ_16
L_sB_15:
  v_add_f32 v240, v224, v225
  v_add_f32 v242, v144, v145
  v_add_f32 v241, v226, v227
  v_add_f32 v243, v146, v147
  v_add_f32 v240, v240, v228
  v_add_f32 v242, v242, v148
  v_add_f32 v241, v241, v229
  v_add_f32 v243, v243, v149
  v_add_f32 v240, v240, v230
  v_add_f32 v242, v242, v150
  v_add_f32 v241, v241, v231
  v_add_f32 v243, v243, v151
  v_add_f32 v240, v240, v232
  v_add_f32 v242, v242, v152
  v_add_f32 v241, v241, v233
  v_add_f32 v243, v243, v153
  v_add_f32 v240, v240, v234
  v_add_f32 v242, v242, v154
  v_add_f32 v241, v241, v235
  v_add_f32 v243, v243, v155
  v_add_f32 v240, v240, v236
  v_add_f32 v242, v242, v156
  v_add_f32 v241, v241, v237
  v_add_f32 v243, v243, v157
  v_add_f32 v240, v240, v241
  v_add_f32 v242, v242, v243
  v_mov_b32 v244, v240
  v_mov_b32 v245, v242
  s_nop 1
  v_permlane32_swap_b32 v240, v244
  v_permlane32_swap_b32 v242, v245
  v_add_f32 v240, v240, v244
  v_add_f32 v242, v242, v245
  v_rcp_f32 v240, v240
  v_rcp_f32 v242, v242
  s_nop 0
  v_mul_f32 v224, v224, v240
  v_mul_f32 v144, v144, v242
  v_mul_f32 v225, v225, v240
  v_mul_f32 v145, v145, v242
  v_mul_f32 v226, v226, v240
  v_mul_f32 v146, v146, v242
  v_mul_f32 v227, v227, v240
  v_mul_f32 v147, v147, v242
  v_mul_f32 v228, v228, v240
  v_mul_f32 v148, v148, v242
  v_mul_f32 v229, v229, v240
  v_mul_f32 v149, v149, v242
  v_mul_f32 v230, v230, v240
  v_mul_f32 v150, v150, v242
  v_mul_f32 v231, v231, v240
  v_mul_f32 v151, v151, v242
  v_mul_f32 v232, v232, v240
  v_mul_f32 v152, v152, v242
  v_mul_f32 v233, v233, v240
  v_mul_f32 v153, v153, v242
  v_mul_f32 v234, v234, v240
  v_mul_f32 v154, v154, v242
  v_mul_f32 v235, v235, v240
  v_mul_f32 v155, v155, v242
  v_mul_f32 v236, v236, v240
  v_mul_f32 v156, v156, v242
  v_mul_f32 v237, v237, v240
  v_mul_f32 v157, v157, v242
  v_cvt_pk_bf16_f32 v208, v224, v225
  v_cvt_pk_bf16_f32 v216, v144, v145
  v_cvt_pk_bf16_f32 v209, v226, v227
  v_cvt_pk_bf16_f32 v217, v146, v147
  v_cvt_pk_bf16_f32 v210, v228, v229
  v_cvt_pk_bf16_f32 v218, v148, v149
  v_cvt_pk_bf16_f32 v211, v230, v231
  v_cvt_pk_bf16_f32 v219, v150, v151
  v_cvt_pk_bf16_f32 v212, v232, v233
  v_cvt_pk_bf16_f32 v220, v152, v153
  v_cvt_pk_bf16_f32 v213, v234, v235
  v_cvt_pk_bf16_f32 v221, v154, v155
  v_cvt_pk_bf16_f32 v214, v236, v237
  v_cvt_pk_bf16_f32 v222, v156, v157
  v_mov_b32 v215, 0
  v_mov_b32 v223, 0
  v_xor_b32 v30, 16, v18
  v_xor_b32 v31, 64, v18
  ds_write_b128 v18, v[208:211]
  ds_write_b128 v30, v[212:215]
  v_xor_b32 v30, 80, v18
  ds_write_b128 v31, v[216:219]
  ds_write_b128 v30, v[220:223]
  ds_read_b64_tr_b16 v[176:177], v16 offset:32768
  ds_read_b64_tr_b16 v[178:179], v16 offset:33024
  ds_read_b64_tr_b16 v[180:181], v16 offset:33792
  ds_read_b64_tr_b16 v[182:183], v16 offset:34048
  ds_read_b64_tr_b16 v[184:185], v16 offset:34816
  ds_read_b64_tr_b16 v[186:187], v16 offset:35072
  ds_read_b64_tr_b16 v[188:189], v16 offset:35840
  ds_read_b64_tr_b16 v[190:191], v16 offset:36096
  ds_read_b64_tr_b16 v[192:193], v16 offset:36864
  ds_read_b64_tr_b16 v[194:195], v16 offset:37120
  ds_read_b64_tr_b16 v[196:197], v16 offset:37888
  ds_read_b64_tr_b16 v[198:199], v16 offset:38144
  ds_read_b64_tr_b16 v[200:201], v16 offset:38912
  ds_read_b64_tr_b16 v[202:203], v16 offset:39168
  s_waitcnt lgkmcnt(12)
  v_mfma_f32_32x32x16_bf16 v[160:175], v[176:179], v[32:35], v[160:175]
  ds_read_b64_tr_b16 v[204:205], v16 offset:39936
  ds_read_b64_tr_b16 v[206:207], v16 offset:40192
  s_waitcnt lgkmcnt(12)
  v_mfma_f32_32x32x16_bf16 v[160:175], v[180:183], v[36:39], v[160:175]
  ds_read_b64_tr_b16 v[176:177], v16 offset:40960
  ds_read_b64_tr_b16 v[178:179], v16 offset:41216
  s_waitcnt lgkmcnt(12)
  v_mfma_f32_32x32x16_bf16 v[160:175], v[184:187], v[40:43], v[160:175]
  ds_read_b64_tr_b16 v[180:181], v16 offset:41984
  ds_read_b64_tr_b16 v[182:183], v16 offset:42240
  s_mul_i32 s32, s91, 1344
  s_add_u32 m0, s67, 4096
  s_nop 0
  buffer_load_dwordx4 v6, s[16:19], s32 offen lds
  s_waitcnt lgkmcnt(12)
  v_mfma_f32_32x32x16_bf16 v[160:175], v[188:191], v[44:47], v[160:175]
  ds_read_b64_tr_b16 v[184:185], v16 offset:43008
  ds_read_b64_tr_b16 v[186:187], v16 offset:43264
  s_waitcnt lgkmcnt(12)
  v_mfma_f32_32x32x16_bf16 v[160:175], v[192:195], v[48:51], v[160:175]
  ds_read_b64_tr_b16 v[188:189], v16 offset:44032
  ds_read_b64_tr_b16 v[190:191], v16 offset:44288
  s_waitcnt lgkmcnt(12)
  v_mfma_f32_32x32x16_bf16 v[160:175], v[196:199], v[52:55], v[160:175]
  ds_read_b64_tr_b16 v[192:193], v16 offset:45056
  ds_read_b64_tr_b16 v[194:195], v16 offset:45312
  s_waitcnt lgkmcnt(12)
  v_mfma_f32_32x32x16_bf16 v[160:175], v[200:203], v[56:59], v[160:175]
  ds_read_b64_tr_b16 v[196:197], v16 offset:46080
  ds_read_b64_tr_b16 v[198:199], v16 offset:46336
  s_waitcnt lgkmcnt(12)
  v_mfma_f32_32x32x16_bf16 v[160:175], v[204:207], v[60:63], v[160:175]
  ds_read_b64_tr_b16 v[200:201], v16 offset:47104
  ds_read_b64_tr_b16 v[202:203], v16 offset:47360
  s_waitcnt lgkmcnt(12)
  v_mfma_f32_32x32x16_bf16 v[160:175], v[176:179], v[64:67], v[160:175]
  ds_read_b64_tr_b16 v[204:205], v16 offset:48128
  ds_read_b64_tr_b16 v[206:207], v16 offset:48384
  s_waitcnt lgkmcnt(12)
  v_mfma_f32_32x32x16_bf16 v[160:175], v[180:183], v[68:71], v[160:175]
  ds_read_b64_tr_b16 v[176:177], v16 offset:49152
  ds_read_b64_tr_b16 v[178:179], v16 offset:49408
  s_waitcnt lgkmcnt(12)
  v_mfma_f32_32x32x16_bf16 v[160:175], v[184:187], v[72:75], v[160:175]
  ds_read_b64_tr_b16 v[180:181], v16 offset:50176
  ds_read_b64_tr_b16 v[182:183], v16 offset:50432
  s_mul_i32 s32, s93, 1344
  s_add_u32 m0, s67, 12288
  s_nop 0
  buffer_load_dwordx4 v6, s[16:19], s32 offen lds
  s_waitcnt lgkmcnt(12)
  v_mfma_f32_32x32x16_bf16 v[160:175], v[188:191], v[76:79], v[160:175]
  ds_read_b64_tr_b16 v[184:185], v16 offset:51200
  ds_read_b64_tr_b16 v[186:187], v16 offset:51456
  s_waitcnt lgkmcnt(12)
  v_mfma_f32_32x32x16_bf16 v[160:175], v[192:195], v[80:83], v[160:175]
  ds_read_b64_tr_b16 v[188:189], v16 offset:52224
  ds_read_b64_tr_b16 v[190:191], v16 offset:52480
  s_waitcnt lgkmcnt(12)
  v_mfma_f32_32x32x16_bf16 v[160:175], v[196:199], v[84:87], v[160:175]
  ds_read_b64_tr_b16 v[192:193], v16 offset:53248
  ds_read_b64_tr_b16 v[194:195], v16 offset:53504
  s_waitcnt lgkmcnt(12)
  v_mfma_f32_32x32x16_bf16 v[160:175], v[200:203], v[88:91], v[160:175]
  ds_read_b64_tr_b16 v[196:197], v16 offset:54272
  ds_read_b64_tr_b16 v[198:199], v16 offset:54528
  s_waitcnt lgkmcnt(12)
  v_mfma_f32_32x32x16_bf16 v[160:175], v[204:207], v[92:95], v[160:175]
  ds_read_b64_tr_b16 v[200:201], v16 offset:55296
  ds_read_b64_tr_b16 v[202:203], v16 offset:55552
  s_waitcnt lgkmcnt(12)
  v_mfma_f32_32x32x16_bf16 v[160:175], v[176:179], v[96:99], v[160:175]
  ds_read_b64_tr_b16 v[204:205], v16 offset:56320
  ds_read_b64_tr_b16 v[206:207], v16 offset:56576
  s_waitcnt lgkmcnt(12)
  v_mfma_f32_32x32x16_bf16 v[160:175], v[180:183], v[100:103], v[160:175]
  ds_read_b64_tr_b16 v[176:177], v16 offset:57344
  ds_read_b64_tr_b16 v[178:179], v16 offset:57600
  s_waitcnt lgkmcnt(12)
  v_mfma_f32_32x32x16_bf16 v[160:175], v[184:187], v[104:107], v[160:175]
  ds_read_b64_tr_b16 v[180:181], v16 offset:58368
  ds_read_b64_tr_b16 v[182:183], v16 offset:58624
  s_mul_i32 s32, s95, 1344
  s_add_u32 m0, s67, 20480
  s_nop 0
  buffer_load_dwordx4 v6, s[16:19], s32 offen lds
  s_waitcnt lgkmcnt(12)
  v_mfma_f32_32x32x16_bf16 v[160:175], v[188:191], v[108:111], v[160:175]
  ds_read_b64_tr_b16 v[184:185], v16 offset:59392
  ds_read_b64_tr_b16 v[186:187], v16 offset:59648
  s_waitcnt lgkmcnt(12)
  v_mfma_f32_32x32x16_bf16 v[160:175], v[192:195], v[112:115], v[160:175]
  ds_read_b64_tr_b16 v[188:189], v16 offset:60416
  ds_read_b64_tr_b16 v[190:191], v16 offset:60672
  s_waitcnt lgkmcnt(12)
  v_mfma_f32_32x32x16_bf16 v[160:175], v[196:199], v[116:119], v[160:175]
  s_waitcnt lgkmcnt(10)
  v_mfma_f32_32x32x16_bf16 v[160:175], v[200:203], v[120:123], v[160:175]
  s_waitcnt lgkmcnt(8)
  v_mfma_f32_32x32x16_bf16 v[160:175], v[204:207], v[124:127], v[160:175]
  s_waitcnt lgkmcnt(6)
  v_mfma_f32_32x32x16_bf16 v[160:175], v[176:179], v[128:131], v[160:175]
  s_waitcnt lgkmcnt(4)
  v_mfma_f32_32x32x16_bf16 v[160:175], v[180:183], v[132:135], v[160:175]
  s_waitcnt lgkmcnt(2)
  v_mfma_f32_32x32x16_bf16 v[160:175], v[184:187], v[136:139], v[160:175]
  s_waitcnt lgkmcnt(0)
  v_mfma_f32_32x32x16_bf16 v[160:175], v[188:191], v[140:143], v[160:175]
  s_lshr_b32 s34, s2, 3
  s_mul_i32 s34, s34, 98
  s_bfe_u32 s35, s31, 0x10001
  s_lshl_b32 s35, s35, 6
  s_add_u32 s34, s34, s35
  v_add_u32 v30, s34, v1
  v_lshlrev_b32 v30, 7, v30
  s_bitcmp1_b32 s31, 0
  s_cselect_b32 s20, s8, s4
  s_cselect_b32 s21, s9, s5
  s_mov_b32 s22, 401408
  s_mov_b32 s23, 0x20000
  s_bitcmp1_b32 s31, 1
  s_cselect_b32 exec_hi, 3, -1
  buffer_load_dword v254, v30, s[20:23], 0 offen
  s_mov_b64 exec, -1
L_sJ_16:
  s_nop 11
  v_cvt_pk_bf16_f32 v246, v160, v161
  v_cvt_pk_bf16_f32 v247, v162, v163
  v_cvt_pk_bf16_f32 v248, v164, v165
  v_cvt_pk_bf16_f32 v249, v166, v167
  v_cvt_pk_bf16_f32 v250, v168, v169
  v_cvt_pk_bf16_f32 v251, v170, v171
  v_cvt_pk_bf16_f32 v252, v172, v173
  v_cvt_pk_bf16_f32 v253, v174, v175
  s_mov_b32 exec_lo, 0
  v_mov_b32 v252, 0x3f803f80
  v_mov_b32 v253, 0
  s_mov_b32 exec_lo, -1
  v_xor_b32 v30, 16, v19
  ds_write_b128 v19, v[246:249]
  ds_write_b128 v30, v[250:253]
  s_waitcnt lgkmcnt(0)
  s_barrier
  ds_read_b64_tr_b16 v[208:209], v20 offset:0
  ds_read_b64_tr_b16 v[210:211], v20 offset:1024
  ds_read_b64_tr_b16 v[144:145], v21 offset:0
  ds_read_b64_tr_b16 v[146:147], v21 offset:512
  ds_read_b64_tr_b16 v[212:213], v20 offset:4096
  ds_read_b64_tr_b16 v[214:215], v20 offset:5120
  ds_read_b64_tr_b16 v[148:149], v21 offset:4096
  ds_read_b64_tr_b16 v[150:151], v21 offset:4608
  ds_read_b64_tr_b16 v[216:217], v20 offset:8192
  ds_read_b64_tr_b16 v[218:219], v20 offset:9216
  ds_read_b64_tr_b16 v[152:153], v21 offset:8192
  ds_read_b64_tr_b16 v[154:155], v21 offset:8704
  s_waitcnt lgkmcnt(8)
  v_mfma_f32_16x16x32_bf16 v[240:243], v[208:211], v[144:147], 0
  ds_read_b64_tr_b16 v[220:221], v20 offset:12288
  ds_read_b64_tr_b16 v[222:223], v20 offset:13312
  ds_read_b64_tr_b16 v[156:157], v21 offset:12288
  ds_read_b64_tr_b16 v[158:159], v21 offset:12800
  s_waitcnt lgkmcnt(8)
  v_mfma_f32_16x16x32_bf16 v[240:243], v[212:215], v[148:151], v[240:243]
  ds_read_b64_tr_b16 v[224:225], v20 offset:16384
  ds_read_b64_tr_b16 v[226:227], v20 offset:17408
  ds_read_b64_tr_b16 v[160:161], v21 offset:16384
  ds_read_b64_tr_b16 v[162:163], v21 offset:16896
  s_waitcnt lgkmcnt(8)
  v_mfma_f32_16x16x32_bf16 v[240:243], v[216:219], v[152:155], v[240:243]
  ds_read_b64_tr_b16 v[228:229], v20 offset:20480
  ds_read_b64_tr_b16 v[230:231], v20 offset:21504
  ds_read_b64_tr_b16 v[164:165], v21 offset:20480
  ds_read_b64_tr_b16 v[166:167], v21 offset:20992
  s_waitcnt lgkmcnt(8)
  v_mfma_f32_16x16x32_bf16 v[240:243], v[220:223], v[156:159], v[240:243]
  ds_read_b64_tr_b16 v[232:233], v20 offset:24576
  ds_read_b64_tr_b16 v[234:235], v20 offset:25600
  ds_read_b64_tr_b16 v[168:169], v21 offset:24576
  ds_read_b64_tr_b16 v[170:171], v21 offset:25088
  s_waitcnt lgkmcnt(8)
  v_mfma_f32_16x16x32_bf16 v[240:243], v[224:227], v[160:163], v[240:243]
  ds_read_b64_tr_b16 v[236:237], v20 offset:28672
  ds_read_b64_tr_b16 v[238:239], v20 offset:29696
  ds_read_b64_tr_b16 v[172:173], v21 offset:28672
  ds_read_b64_tr_b16 v[174:175], v21 offset:29184
  s_waitcnt lgkmcnt(8)
  v_mfma_f32_16x16x32_bf16 v[240:243], v[228:231], v[164:167], v[240:243]
  s_add_u32 s48, s48, 0x00010001
  s_lshr_b32 s49, s48, 16
  s_and_b32 s49, s49, 0xbfff
  s_lshl_b32 s49, s49, 16
  s_lshl_b32 s34, s69, 3
  s_add_u32 s34, s34, s30
  s_lshl_b32 s34, s34, 13
  s_lshl_b32 s35, s31, 10
  s_add_u32 s34, s34, s35
  s_add_u32 s34, s34, 65536
  s_waitcnt lgkmcnt(4)
  v_mfma_f32_16x16x32_bf16 v[240:243], v[232:235], v[168:171], v[240:243]
  s_waitcnt lgkmcnt(0)
  v_mfma_f32_16x16x32_bf16 v[240:243], v[236:239], v[172:175], v[240:243]
  v_mov_b32 v245, s48
  v_mov_b32 v247, s48
  s_nop 5
  v_cvt_pk_bf16_f32 v244, v240, v241
  v_cvt_pk_bf16_f32 v246, v242, v243
  buffer_store_dwordx4 v[244:247], v7, s[24:27], s34 offen sc1
  s_waitcnt vmcnt(3)
  s_cmp_lg_u32 s69, 0
  s_cbranch_scc1 L_gp_17
  v_lshrrev_b32 v30, 4, v1
  v_lshlrev_b32 v30, 13, v30
  v_and_b32 v31, 15, v1
  v_lshl_add_u32 v30, v31, 6, v30
  s_lshl_b32 s34, s59, 12
  s_add_u32 s34, s34, s67
  v_add_u32 v30, s34, v30
  v_add_u32 v30, 48, v30
  v_mov_b32 v240, v17
  v_mov_b32 v241, 0
  s_mov_b32 exec_hi, 0
  ds_write_b64 v30, v[240:241]
  s_mov_b64 exec, -1
L_gp_17:
  s_waitcnt lgkmcnt(0)
  s_barrier
  ds_read_b64_tr_b16 v[176:177], v16 offset:0
  ds_read_b64_tr_b16 v[178:179], v16 offset:256
  ds_read_b64_tr_b16 v[180:181], v16 offset:1024
  ds_read_b64_tr_b16 v[182:183], v16 offset:1280
  ds_read_b64_tr_b16 v[184:185], v16 offset:2048
  ds_read_b64_tr_b16 v[186:187], v16 offset:2304
  ds_read_b64_tr_b16 v[188:189], v16 offset:3072
  ds_read_b64_tr_b16 v[190:191], v16 offset:3328
  ds_read_b64_tr_b16 v[160:161], v16 offset:4096
  ds_read_b64_tr_b16 v[162:163], v16 offset:4352
  ds_read_b64_tr_b16 v[164:165], v16 offset:5120
  ds_read_b64_tr_b16 v[166:167], v16 offset:5376
  ds_read_b64_tr_b16 v[168:169], v16 offset:6144
  ds_read_b64_tr_b16 v[170:171], v16 offset:6400
  s_waitcnt lgkmcnt(12)
  v_mfma_f32_32x32x16_bf16 v[192:207], v[176:179], v[32:35], 0
  ds_read_b64_tr_b16 v[172:173], v16 offset:7168
  ds_read_b64_tr_b16 v[174:175], v16 offset:7424
  s_waitcnt lgkmcnt(12)
  v_mfma_f32_32x32x16_bf16 v[192:207], v[180:183], v[36:39], v[192:207]
  ds_read_b64_tr_b16 v[176:177], v16 offset:8192
  ds_read_b64_tr_b16 v[178:179], v16 offset:8448
  s_add_u32 m0, s56, 32768
  s_add_u32 s32, s39, 0
  buffer_load_dwordx4 v24, s[4:7], s32 offen offset:0 lds
  s_waitcnt lgkmcnt(12)
  v_mfma_f32_32x32x16_bf16 v[192:207], v[184:187], v[40:43], v[192:207]
  ds_read_b64_tr_b16 v[180:181], v16 offset:9216
  ds_read_b64_tr_b16 v[182:183], v16 offset:9472
  s_waitcnt lgkmcnt(12)
  v_mfma_f32_32x32x16_bf16 v[192:207], v[188:191], v[44:47], v[192:207]
  ds_read_b64_tr_b16 v[184:185], v16 offset:10240
  ds_read_b64_tr_b16 v[186:187], v16 offset:10496
  s_add_u32 s32, s39, 11520
  buffer_load_dwordx4 v24, s[4:7], s32 offen offset:1024 lds
  s_waitcnt lgkmcnt(12)
  v_mfma_f32_32x32x16_bf16 v[192:207], v[160:163], v[48:51], v[192:207]
  ds_read_b64_tr_b16 v[188:189], v16 offset:11264
  ds_read_b64_tr_b16 v[190:191], v16 offset:11520
  s_waitcnt lgkmcnt(12)
  v_mfma_f32_32x32x16_bf16 v[192:207], v[164:167], v[52:55], v[192:207]
  ds_read_b64_tr_b16 v[160:161], v16 offset:12288
  ds_read_b64_tr_b16 v[162:163], v16 offset:12544
  s_add_u32 s32, s39, 4224
  buffer_load_dwordx4 v24, s[4:7], s32 offen offset:2048 lds
  s_waitcnt lgkmcnt(12)
  v_mfma_f32_32x32x16_bf16 v[192:207], v[168:171], v[56:59], v[192:207]
  ds_read_b64_tr_b16 v[164:165], v16 offset:13312
  ds_read_b64_tr_b16 v[166:167], v16 offset:13568
  s_waitcnt lgkmcnt(12)
  v_mfma_f32_32x32x16_bf16 v[192:207], v[172:175], v[60:63], v[192:207]
  ds_read_b64_tr_b16 v[168:169], v16 offset:14336
  ds_read_b64_tr_b16 v[170:171], v16 offset:14592
  s_add_u32 s32, s39, 15744
  buffer_load_dwordx4 v24, s[4:7], s32 offen offset:3072 lds
  s_waitcnt lgkmcnt(12)
  v_mfma_f32_32x32x16_bf16 v[192:207], v[176:179], v[64:67], v[192:207]
  ds_read_b64_tr_b16 v[172:173], v16 offset:15360
  ds_read_b64_tr_b16 v[174:175], v16 offset:15616
  s_waitcnt lgkmcnt(12)
  v_mfma_f32_32x32x16_bf16 v[192:207], v[180:183], v[68:71], v[192:207]
  s_add_u32 m0, s56, 98304
  s_add_u32 s32, s39, 0
  buffer_load_dwordx4 v24, s[8:11], s32 offen offset:0 lds
  s_waitcnt lgkmcnt(10)
  v_mfma_f32_32x32x16_bf16 v[192:207], v[184:187], v[72:75], v[192:207]
  s_waitcnt lgkmcnt(8)
  v_mfma_f32_32x32x16_bf16 v[192:207], v[188:191], v[76:79], v[192:207]
  s_add_u32 s32, s39, 11520
  buffer_load_dwordx4 v24, s[8:11], s32 offen offset:1024 lds
  s_waitcnt lgkmcnt(6)
  v_mfma_f32_32x32x16_bf16 v[192:207], v[160:163], v[80:83], v[192:207]
  s_waitcnt lgkmcnt(4)
  v_mfma_f32_32x32x16_bf16 v[192:207], v[164:167], v[84:87], v[192:207]
  s_add_u32 s32, s39, 4224
  buffer_load_dwordx4 v24, s[8:11], s32 offen offset:2048 lds
  s_waitcnt lgkmcnt(2)
  v_mfma_f32_32x32x16_bf16 v[192:207], v[168:171], v[88:91], v[192:207]
  s_waitcnt lgkmcnt(0)
  v_mfma_f32_32x32x16_bf16 v[192:207], v[172:175], v[92:95], v[192:207]
  s_add_u32 s32, s39, 15744
  buffer_load_dwordx4 v24, s[8:11], s32 offen offset:3072 lds
  s_waitcnt vmcnt(9)
  s_cmp_lg_u32 s69, 0
  s_cbranch_scc1 L_gp_18
  v_lshrrev_b32 v30, 4, v1
  v_lshlrev_b32 v30, 13, v30
  v_and_b32 v31, 15, v1
  v_lshl_add_u32 v30, v31, 6, v30
  s_lshl_b32 s34, s59, 12
  s_add_u32 s34, s34, s67
  v_add_u32 v30, s34, v30
  v_add_u32 v30, 16432, v30
  v_mov_b32 v240, v27
  v_mov_b32 v241, 0
  s_mov_b32 exec_hi, 0
  s_cmp_eq_u32 s59, 1
  s_cselect_b32 exec_lo, 0xffff, -1
  ds_write_b64 v30, v[240:241]
  s_mov_b64 exec, -1
L_gp_18:
  s_waitcnt lgkmcnt(0)
  s_barrier
  ds_read_b64_tr_b16 v[176:177], v16 offset:16384
  ds_read_b64_tr_b16 v[178:179], v16 offset:16640
  ds_read_b64_tr_b16 v[180:181], v16 offset:17408
  ds_read_b64_tr_b16 v[182:183], v16 offset:17664
  ds_read_b64_tr_b16 v[184:185], v16 offset:18432
  ds_read_b64_tr_b16 v[186:187], v16 offset:18688
  ds_read_b64_tr_b16 v[188:189], v16 offset:19456
  ds_read_b64_tr_b16 v[190:191], v16 offset:19712
  ds_read_b64_tr_b16 v[160:161], v16 offset:20480
  ds_read_b64_tr_b16 v[162:163], v16 offset:20736
  ds_read_b64_tr_b16 v[164:165], v16 offset:21504
  ds_read_b64_tr_b16 v[166:167], v16 offset:21760
  ds_read_b64_tr_b16 v[168:169], v16 offset:22528
  ds_read_b64_tr_b16 v[170:171], v16 offset:22784
  s_waitcnt lgkmcnt(12)
  v_mfma_f32_32x32x16_bf16 v[192:207], v[176:179], v[96:99], v[192:207]
  ds_read_b64_tr_b16 v[172:173], v16 offset:23552
  ds_read_b64_tr_b16 v[174:175], v16 offset:23808
  s_add_u32 m0, s56, 65536
  s_add_u32 s32, s39, 200704
  buffer_load_dwordx4 v24, s[4:7], s32 offen offset:0 lds
  s_waitcnt lgkmcnt(12)
  v_mfma_f32_32x32x16_bf16 v[192:207], v[180:183], v[100:103], v[192:207]
  ds_read_b64_tr_b16 v[176:177], v16 offset:24576
  ds_read_b64_tr_b16 v[178:179], v16 offset:24832
  s_waitcnt lgkmcnt(12)
  v_mfma_f32_32x32x16_bf16 v[192:207], v[184:187], v[104:107], v[192:207]
  ds_read_b64_tr_b16 v[180:181], v16 offset:25600
  ds_read_b64_tr_b16 v[182:183], v16 offset:25856
  s_add_u32 s32, s39, 212224
  buffer_load_dwordx4 v24, s[4:7], s32 offen offset:1024 lds
  s_waitcnt lgkmcnt(12)
  v_mfma_f32_32x32x16_bf16 v[192:207], v[188:191], v[108:111], v[192:207]
  ds_read_b64_tr_b16 v[184:185], v16 offset:26624
  ds_read_b64_tr_b16 v[186:187], v16 offset:26880
  s_add_u32 s32, s39, 204928
  buffer_load_dwordx4 v24, s[4:7], s32 offen offset:2048 lds
  s_waitcnt lgkmcnt(12)
  v_mfma_f32_32x32x16_bf16 v[192:207], v[160:163], v[112:115], v[192:207]
  ds_read_b64_tr_b16 v[188:189], v16 offset:27648
  ds_read_b64_tr_b16 v[190:191], v16 offset:27904
  s_waitcnt lgkmcnt(12)
  v_mfma_f32_32x32x16_bf16 v[192:207], v[164:167], v[116:119], v[192:207]
  s_add_u32 s32, s39, 216448
  buffer_load_dwordx4 v24, s[4:7], s32 offen offset:3072 lds
  s_waitcnt lgkmcnt(10)
  v_mfma_f32_32x32x16_bf16 v[192:207], v[168:171], v[120:123], v[192:207]
  s_add_u32 m0, s56, 131072
  s_add_u32 s32, s39, 200704
  buffer_load_dwordx4 v24, s[8:11], s32 offen offset:0 lds
  s_waitcnt lgkmcnt(8)
  v_mfma_f32_32x32x16_bf16 v[192:207], v[172:175], v[124:127], v[192:207]
  s_waitcnt lgkmcnt(6)
  v_mfma_f32_32x32x16_bf16 v[192:207], v[176:179], v[128:131], v[192:207]
  s_add_u32 s32, s39, 212224
  buffer_load_dwordx4 v24, s[8:11], s32 offen offset:1024 lds
  s_waitcnt lgkmcnt(4)
  v_mfma_f32_32x32x16_bf16 v[192:207], v[180:183], v[132:135], v[192:207]
  s_add_u32 s32, s39, 204928
  buffer_load_dwordx4 v24, s[8:11], s32 offen offset:2048 lds
  s_waitcnt lgkmcnt(2)
  v_mfma_f32_32x32x16_bf16 v[192:207], v[184:187], v[136:139], v[192:207]
  s_waitcnt lgkmcnt(0)
  v_mfma_f32_32x32x16_bf16 v[192:207], v[188:191], v[140:143], v[192:207]
  s_add_u32 s32, s39, 216448
  buffer_load_dwordx4 v24, s[8:11], s32 offen offset:3072 lds
  ds_read_b128 v[216:219], v7 offset:30720
  ds_read_b128 v[220:223], v7 offset:31744
  s_lshl_b32 s34, s69, 16
  s_lshl_b32 s35, s31, 10
  s_add_u32 s34, s34, s35
  s_add_u32 s36, s34, 65536
  s_nop 6
  v_cvt_pk_bf16_f32 v208, v192, v193
  v_cvt_pk_bf16_f32 v209, v194, v195
  v_cvt_pk_bf16_f32 v210, v196, v197
  v_cvt_pk_bf16_f32 v211, v198, v199
  v_cvt_pk_bf16_f32 v212, v200, v201
  v_cvt_pk_bf16_f32 v213, v202, v203
  v_cvt_pk_bf16_f32 v214, v204, v205
  v_cvt_pk_bf16_f32 v215, v206, v207
  s_waitcnt lgkmcnt(0)
  v_mfma_f32_32x32x16_bf16 v[144:159], v[216:219], v[208:211], 0
  v_mfma_f32_32x32x16_bf16 v[144:159], v[220:223], v[212:215], v[144:159]
  s_cmp_lg_u32 s69, 0
  s_cbranch_scc1 L_nogate_19
  v_mul_f32 v30, s50, v204
  v_sub_f32 v30, 0, v30
  v_exp_f32 v30, v30
  s_nop 0
  v_add_f32 v30, 1.0, v30
  v_rcp_f32 v30, v30
  v_mov_b32 v31, s48
  v_and_b32 v240, 31, v1
  s_lshl_b32 s34, s30, 8
  s_lshl_b32 s35, s31, 5
  s_add_u32 s34, s34, s35
  v_add_u32 v240, s34, v240
  v_lshlrev_b32 v240, 3, v240
  v_add_u32 v240, 3145728, v240
  s_mov_b32 exec_lo, 0
  buffer_store_dwordx2 v[30:31], v240, s[24:27], 0 offen sc1
  s_mov_b32 exec_lo, -1
L_nogate_19:
  s_nop 13
  v_max3_f32 v240, v144, v145, v146
  v_min3_f32 v242, v144, v145, v146
  v_max3_f32 v244, v147, v148, v149
  v_min3_f32 v245, v147, v148, v149
  v_max3_f32 v240, v240, v150, v151
  v_min3_f32 v242, v242, v150, v151
  v_max3_f32 v244, v244, v152, v153
  v_min3_f32 v245, v245, v152, v153
  v_max3_f32 v240, v240, v154, v155
  v_min3_f32 v242, v242, v154, v155
  s_add_u32 s32, s36, 0
  buffer_load_dwordx4 v[176:179], v7, s[24:27], s32 offen sc1
  v_max3_f32 v244, v244, v156, v157
  v_min3_f32 v245, v245, v156, v157
  v_max_f32 v240, v240, v244
  v_min_f32 v242, v242, v245
  v_mov_b32 v244, v240
  v_mov_b32 v245, v242
  s_nop 1
  v_permlane32_swap_b32 v240, v244
  v_permlane32_swap_b32 v242, v245
  v_max_f32 v240, v240, v244
  s_add_u32 s32, s36, 8192
  buffer_load_dwordx4 v[180:183], v7, s[24:27], s32 offen sc1
  v_min_f32 v242, v242, v245
  v_mul_f32 v240, s50, v240
  v_mul_f32 v242, s50, v242
  v_pk_fma_f32 v[224:225], v[144:145], s[50:51], v[240:241] op_sel_hi:[1,0,0] neg_lo:[0,0,1] neg_hi:[0,0,1]
  v_pk_fma_f32 v[144:145], v[144:145], s[50:51], v[242:243] op_sel_hi:[1,0,0] neg_lo:[1,0,0] neg_hi:[1,0,0]
  v_pk_fma_f32 v[226:227], v[146:147], s[50:51], v[240:241] op_sel_hi:[1,0,0] neg_lo:[0,0,1] neg_hi:[0,0,1]
  v_pk_fma_f32 v[146:147], v[146:147], s[50:51], v[242:243] op_sel_hi:[1,0,0] neg_lo:[1,0,0] neg_hi:[1,0,0]
  v_pk_fma_f32 v[228:229], v[148:149], s[50:51], v[240:241] op_sel_hi:[1,0,0] neg_lo:[0,0,1] neg_hi:[0,0,1]
  s_add_u32 s32, s36, 16384
  buffer_load_dwordx4 v[184:187], v7, s[24:27], s32 offen sc1
  v_pk_fma_f32 v[148:149], v[148:149], s[50:51], v[242:243] op_sel_hi:[1,0,0] neg_lo:[1,0,0] neg_hi:[1,0,0]
  v_pk_fma_f32 v[230:231], v[150:151], s[50:51], v[240:241] op_sel_hi:[1,0,0] neg_lo:[0,0,1] neg_hi:[0,0,1]
  v_pk_fma_f32 v[150:151], v[150:151], s[50:51], v[242:243] op_sel_hi:[1,0,0] neg_lo:[1,0,0] neg_hi:[1,0,0]
  v_pk_fma_f32 v[232:233], v[152:153], s[50:51], v[240:241] op_sel_hi:[1,0,0] neg_lo:[0,0,1] neg_hi:[0,0,1]
  v_pk_fma_f32 v[152:153], v[152:153], s[50:51], v[242:243] op_sel_hi:[1,0,0] neg_lo:[1,0,0] neg_hi:[1,0,0]
  v_pk_fma_f32 v[234:235], v[154:155], s[50:51], v[240:241] op_sel_hi:[1,0,0] neg_lo:[0,0,1] neg_hi:[0,0,1]
  v_pk_fma_f32 v[154:155], v[154:155], s[50:51], v[242:243] op_sel_hi:[1,0,0] neg_lo:[1,0,0] neg_hi:[1,0,0]
  v_pk_fma_f32 v[236:237], v[156:157], s[50:51], v[240:241] op_sel_hi:[1,0,0] neg_lo:[0,0,1] neg_hi:[0,0,1]
  s_add_u32 s32, s36, 24576
  buffer_load_dwordx4 v[188:191], v7, s[24:27], s32 offen sc1
  v_pk_fma_f32 v[156:157], v[156:157], s[50:51], v[242:243] op_sel_hi:[1,0,0] neg_lo:[1,0,0] neg_hi:[1,0,0]
  v_exp_f32 v224, v224
  v_exp_f32 v144, v144
  v_exp_f32 v225, v225
  v_exp_f32 v145, v145
  v_exp_f32 v226, v226
  v_exp_f32 v146, v146
  v_exp_f32 v227, v227
  s_add_u32 s32, s36, 32768
  buffer_load_dwordx4 v[192:195], v7, s[24:27], s32 offen sc1
  v_exp_f32 v147, v147
  v_exp_f32 v228, v228
  v_exp_f32 v148, v148
  v_exp_f32 v229, v229
  v_exp_f32 v149, v149
  v_exp_f32 v230, v230
  v_exp_f32 v150, v150
  v_exp_f32 v231, v231
  s_add_u32 s32, s36, 40960
  buffer_load_dwordx4 v[196:199], v7, s[24:27], s32 offen sc1
  v_exp_f32 v151, v151
  v_exp_f32 v232, v232
  v_exp_f32 v152, v152
  v_exp_f32 v233, v233
  v_exp_f32 v153, v153
  v_exp_f32 v234, v234
  v_exp_f32 v154, v154
  v_exp_f32 v235, v235
  s_add_u32 s32, s36, 49152
  buffer_load_dwordx4 v[200:203], v7, s[24:27], s32 offen sc1
  v_exp_f32 v155, v155
  v_exp_f32 v236, v236
  v_exp_f32 v156, v156
  v_exp_f32 v237, v237
  v_exp_f32 v157, v157
  s_nop 0
  v_cvt_pk_bf16_f32 v208, v224, v225
  v_cvt_pk_bf16_f32 v216, v144, v145
  s_add_u32 s32, s36, 57344
  buffer_load_dwordx4 v[204:207], v7, s[24:27], s32 offen sc1
  v_cvt_pk_bf16_f32 v209, v226, v227
  v_cvt_pk_bf16_f32 v217, v146, v147
  v_cvt_pk_bf16_f32 v210, v228, v229
  v_cvt_pk_bf16_f32 v218, v148, v149
  v_cvt_pk_bf16_f32 v211, v230, v231
  v_cvt_pk_bf16_f32 v219, v150, v151
  v_cvt_pk_bf16_f32 v212, v232, v233
  v_cvt_pk_bf16_f32 v220, v152, v153
  v_cvt_pk_bf16_f32 v213, v234, v235
  v_cvt_pk_bf16_f32 v221, v154, v155
  v_cvt_pk_bf16_f32 v214, v236, v237
  v_cvt_pk_bf16_f32 v222, v156, v157
  v_mov_b32 v215, 0
  v_mov_b32 v223, 0
  s_mov_b32 s37, 65536
L_x1:
  s_waitcnt vmcnt(0)
  v_xor_b32 v30, s48, v179
  v_xor_b32 v31, s48, v183
  v_xor_b32 v224, s48, v187
  v_xor_b32 v225, s48, v191
  v_or3_b32 v30, v30, v224, v225
  v_xor_b32 v224, s48, v195
  v_xor_b32 v225, s48, v199
  v_or3_b32 v30, v30, v224, v225
  v_xor_b32 v224, s48, v203
  v_xor_b32 v225, s48, v207
  v_or3_b32 v30, v30, v224, v225
  v_or_b32 v30, v30, v31
  v_cmp_ne_u32 vcc, 0, v30
  s_cbranch_vccz L_x1ok
  s_sub_u32 s37, s37, 1
  s_cmp_eq_u32 s37, 0
  s_cbranch_scc1 L_x1ok
  s_add_u32 s32, s36, 0
  buffer_load_dwordx4 v[176:179], v7, s[24:27], s32 offen sc1
  s_add_u32 s32, s36, 8192
  buffer_load_dwordx4 v[180:183], v7, s[24:27], s32 offen sc1
  s_add_u32 s32, s36, 16384
  buffer_load_dwordx4 v[184:187], v7, s[24:27], s32 offen sc1
  s_add_u32 s32, s36, 24576
  buffer_load_dwordx4 v[188:191], v7, s[24:27], s32 offen sc1
  s_add_u32 s32, s36, 32768
  buffer_load_dwordx4 v[192:195], v7, s[24:27], s32 offen sc1
  s_add_u32 s32, s36, 40960
  buffer_load_dwordx4 v[196:199], v7, s[24:27], s32 offen sc1
  s_add_u32 s32, s36, 49152
  buffer_load_dwordx4 v[200:203], v7, s[24:27], s32 offen sc1
  s_add_u32 s32, s36, 57344
  buffer_load_dwordx4 v[204:207], v7, s[24:27], s32 offen sc1
  s_branch L_x1
L_x1ok:
  v_lshlrev_b32 v240, 16, v176
  v_and_b32 v241, 0xffff0000, v176
  v_lshlrev_b32 v242, 16, v178
  v_and_b32 v243, 0xffff0000, v178
  v_lshlrev_b32 v246, 16, v180
  v_and_b32 v247, 0xffff0000, v180
  v_pk_add_f32 v[240:241], v[240:241], v[246:247]
  v_lshlrev_b32 v250, 16, v182
  v_and_b32 v251, 0xffff0000, v182
  v_pk_add_f32 v[242:243], v[242:243], v[250:251]
  v_lshlrev_b32 v244, 16, v184
  v_and_b32 v245, 0xffff0000, v184
  v_pk_add_f32 v[240:241], v[240:241], v[244:245]
  v_lshlrev_b32 v248, 16, v186
  v_and_b32 v249, 0xffff0000, v186
  v_pk_add_f32 v[242:243], v[242:243], v[248:249]
  v_lshlrev_b32 v246, 16, v188
  v_and_b32 v247, 0xffff0000, v188
  v_pk_add_f32 v[240:241], v[240:241], v[246:247]
  v_lshlrev_b32 v250, 16, v190
  v_and_b32 v251, 0xffff0000, v190
  v_pk_add_f32 v[242:243], v[242:243], v[250:251]
  v_lshlrev_b32 v244, 16, v192
  v_and_b32 v245, 0xffff0000, v192
  v_pk_add_f32 v[240:241], v[240:241], v[244:245]
  v_lshlrev_b32 v248, 16, v194
  v_and_b32 v249, 0xffff0000, v194
  v_pk_add_f32 v[242:243], v[242:243], v[248:249]
  v_lshlrev_b32 v246, 16, v196
  v_and_b32 v247, 0xffff0000, v196
  v_pk_add_f32 v[240:241], v[240:241], v[246:247]
  v_lshlrev_b32 v250, 16, v198
  v_and_b32 v251, 0xffff0000, v198
  v_pk_add_f32 v[242:243], v[242:243], v[250:251]
  v_lshlrev_b32 v244, 16, v200
  v_and_b32 v245, 0xffff0000, v200
  v_pk_add_f32 v[240:241], v[240:241], v[244:245]
  v_lshlrev_b32 v248, 16, v202
  v_and_b32 v249, 0xffff0000, v202
  v_pk_add_f32 v[242:243], v[242:243], v[248:249]
  v_lshlrev_b32 v246, 16, v204
  v_and_b32 v247, 0xffff0000, v204
  v_pk_add_f32 v[240:241], v[240:241], v[246:247]
  v_lshlrev_b32 v250, 16, v206
  v_and_b32 v251, 0xffff0000, v206
  v_pk_add_f32 v[242:243], v[242:243], v[250:251]
  v_cvt_pk_bf16_f32 v244, v240, v241
  v_cvt_pk_bf16_f32 v245, v242, v243
  v_mov_b32 v246, 0x3f803f80
  v_cndmask_b32 v244, v244, v246, s[64:65]
  v_cndmask_b32 v245, v245, v23, s[64:65]
  ds_write_b64 v22, v[244:245]
  s_waitcnt lgkmcnt(0)
  s_barrier
  ds_read_b128 v[224:227], v7 offset:0
  ds_read_b128 v[228:231], v7 offset:1024
  ds_read_b128 v[232:235], v7 offset:2048
  ds_read_b128 v[236:239], v7 offset:3072
  s_lshl_b32 s34, s28, 6
  s_lshl_b32 s35, s30, 3
  s_add_u32 s34, s34, s35
  s_add_u32 s34, s34, s31
  s_lshl_b32 s34, s34, 4
  s_add_u32 s34, s34, s29
  s_lshl_b32 s34, s34, 11
  s_add_u32 s34, s34, 4194304
  s_waitcnt lgkmcnt(2)
  v_mfma_f32_32x32x16_bf16 v[160:175], v[224:227], v[208:211], 0
  v_mfma_f32_32x32x16_bf16 v[160:175], v[228:231], v[212:215], v[160:175]
  s_waitcnt lgkmcnt(0)
  v_mfma_f32_32x32x16_bf16 v[176:191], v[232:235], v[216:219], 0
  v_mfma_f32_32x32x16_bf16 v[176:191], v[236:239], v[220:223], v[176:191]
  v_mov_b32 v240, s49
  v_mov_b32 v241, 0xffff
  s_mov_b32 s35, 0x358637bd
  s_lshl_b32 s36, s58, 6
  s_lshl_b32 s37, s53, 1
  s_add_u32 s36, s36, s37
  s_add_u32 s36, s36, s57
  s_lshl_b32 s36, s36, 4
  s_lshl_b32 s37, s59, 3
  s_add_u32 s36, s36, s37
  s_lshl_b32 s36, s36, 11
  s_add_u32 s36, s36, 4194304
  v_mov_b32 v224, 0
  v_mov_b32 v225, 0
  v_mov_b32 v226, 0
  v_mov_b32 v227, 0
  v_mov_b32 v228, 0
  v_mov_b32 v229, 0
  v_mov_b32 v230, 0
  v_mov_b32 v231, 0
  v_mov_b32 v232, 0
  v_mov_b32 v233, 0
  v_mov_b32 v234, 0
  v_mov_b32 v235, 0
  v_mov_b32 v236, 0
  v_mov_b32 v237, 0
  v_mov_b32 v238, 0
  v_mov_b32 v239, 0
  v_mov_b32 v246, 0
  v_mov_b32 v247, 0
  v_mov_b32 v248, 0
  v_mov_b32 v249, 0
  v_mov_b32 v250, 0
  v_mov_b32 v251, 0
  v_mov_b32 v252, 0
  v_mov_b32 v253, 0
  v_mov_b32 v254, 0
  v_mov_b32 v255, 0
  v_mul_f32 v30, v174, v191
  v_mul_f32 v31, v175, v191
  v_fma_f32 v30, v190, v175, v30
  v_fma_f32 v30, v31, s35, v30
  v_rcp_f32 v30, v30
  s_nop 0
  v_mul_f32 v242, v191, v30
  v_mul_f32 v244, v175, v30
  v_pk_mul_f32 v[160:161], v[160:161], v[242:243] op_sel_hi:[1,0]
  v_pk_mul_f32 v[162:163], v[162:163], v[242:243] op_sel_hi:[1,0]
  v_pk_mul_f32 v[164:165], v[164:165], v[242:243] op_sel_hi:[1,0]
  v_pk_mul_f32 v[166:167], v[166:167], v[242:243] op_sel_hi:[1,0]
  v_pk_mul_f32 v[168:169], v[168:169], v[242:243] op_sel_hi:[1,0]
  v_pk_mul_f32 v[170:171], v[170:171], v[242:243] op_sel_hi:[1,0]
  v_pk_mul_f32 v[172:173], v[172:173], v[242:243] op_sel_hi:[1,0]
  v_pk_fma_f32 v[160:161], v[176:177], v[244:245], v[160:161] op_sel_hi:[1,0,1]
  v_pk_fma_f32 v[162:163], v[178:179], v[244:245], v[162:163] op_sel_hi:[1,0,1]
  v_pk_fma_f32 v[164:165], v[180:181], v[244:245], v[164:165] op_sel_hi:[1,0,1]
  v_pk_fma_f32 v[166:167], v[182:183], v[244:245], v[166:167] op_sel_hi:[1,0,1]
  v_pk_fma_f32 v[168:169], v[184:185], v[244:245], v[168:169] op_sel_hi:[1,0,1]
  v_pk_fma_f32 v[170:171], v[186:187], v[244:245], v[170:171] op_sel_hi:[1,0,1]
  v_pk_fma_f32 v[172:173], v[188:189], v[244:245], v[172:173] op_sel_hi:[1,0,1]
  v_cvt_pk_bf16_f32 v192, v160, v161
  v_cvt_pk_bf16_f32 v193, v162, v163
  v_cvt_pk_bf16_f32 v194, v164, v165
  v_cvt_pk_bf16_f32 v195, v166, v166
  v_bfi_b32 v195, v241, v195, v240
  buffer_store_dwordx4 v[192:195], v7, s[24:27], s34 offen offset:0 sc1
  v_cvt_pk_bf16_f32 v196, v167, v168
  v_cvt_pk_bf16_f32 v197, v169, v170
  v_cvt_pk_bf16_f32 v198, v171, v172
  v_cvt_pk_bf16_f32 v199, v173, v173
  v_bfi_b32 v199, v241, v199, v240
  buffer_store_dwordx4 v[196:199], v7, s[24:27], s34 offen offset:1024 sc1
  s_cmp_ge_u32 s52, 7
  s_cbranch_scc1 L_fin
  v_mov_b32 v240, 0
  v_mov_b32 v241, 0
  v_mov_b32 v242, 0
  v_mov_b32 v243, 0
  v_mov_b32 v244, 0
  v_mov_b32 v245, 0
  s_mov_b32 s55, 0
  s_mov_b32 s37, 65536
  s_barrier
  s_bfe_u32 s32, s3, 262144
  s_lshl_b32 s32, s32, 12
  v_add_u32 v2, s32, v25
  v_add_u32 v3, s32, v26
  ds_read_b64_tr_b16 v[32:33], v2 offset:0
  ds_read_b64_tr_b16 v[34:35], v2 offset:512
  ds_read_b64_tr_b16 v[36:37], v3 offset:0
  ds_read_b64_tr_b16 v[38:39], v3 offset:512
  ds_read_b64_tr_b16 v[40:41], v2 offset:2048
  ds_read_b64_tr_b16 v[42:43], v2 offset:2560
  ds_read_b64_tr_b16 v[44:45], v3 offset:2048
  ds_read_b64_tr_b16 v[46:47], v3 offset:2560
  s_bfe_u32 s32, s3, 262148
  s_lshl_b32 s32, s32, 12
  v_add_u32 v2, s32, v25
  v_add_u32 v3, s32, v26
  ds_read_b64_tr_b16 v[48:49], v2 offset:0
  ds_read_b64_tr_b16 v[50:51], v2 offset:512
  ds_read_b64_tr_b16 v[52:53], v3 offset:0
  ds_read_b64_tr_b16 v[54:55], v3 offset:512
  ds_read_b64_tr_b16 v[56:57], v2 offset:2048
  ds_read_b64_tr_b16 v[58:59], v2 offset:2560
  ds_read_b64_tr_b16 v[60:61], v3 offset:2048
  ds_read_b64_tr_b16 v[62:63], v3 offset:2560
  s_bfe_u32 s32, s3, 262152
  s_lshl_b32 s32, s32, 12
  v_add_u32 v2, s32, v25
  v_add_u32 v3, s32, v26
  ds_read_b64_tr_b16 v[64:65], v2 offset:0
  ds_read_b64_tr_b16 v[66:67], v2 offset:512
  ds_read_b64_tr_b16 v[68:69], v3 offset:0
  ds_read_b64_tr_b16 v[70:71], v3 offset:512
  ds_read_b64_tr_b16 v[72:73], v2 offset:2048
  ds_read_b64_tr_b16 v[74:75], v2 offset:2560
  ds_read_b64_tr_b16 v[76:77], v3 offset:2048
  ds_read_b64_tr_b16 v[78:79], v3 offset:2560
  s_bfe_u32 s32, s3, 262156
  s_lshl_b32 s32, s32, 12
  v_add_u32 v2, s32, v25
  v_add_u32 v3, s32, v26
  ds_read_b64_tr_b16 v[80:81], v2 offset:0
  ds_read_b64_tr_b16 v[82:83], v2 offset:512
  ds_read_b64_tr_b16 v[84:85], v3 offset:0
  ds_read_b64_tr_b16 v[86:87], v3 offset:512
  ds_read_b64_tr_b16 v[88:89], v2 offset:2048
  ds_read_b64_tr_b16 v[90:91], v2 offset:2560
  ds_read_b64_tr_b16 v[92:93], v3 offset:2048
  ds_read_b64_tr_b16 v[94:95], v3 offset:2560
  s_bfe_u32 s32, s3, 262160
  s_lshl_b32 s32, s32, 12
  v_add_u32 v2, s32, v25
  v_add_u32 v3, s32, v26
  ds_read_b64_tr_b16 v[96:97], v2 offset:0
  ds_read_b64_tr_b16 v[98:99], v2 offset:512
  ds_read_b64_tr_b16 v[100:101], v3 offset:0
  ds_read_b64_tr_b16 v[102:103], v3 offset:512
  ds_read_b64_tr_b16 v[104:105], v2 offset:2048
  ds_read_b64_tr_b16 v[106:107], v2 offset:2560
  ds_read_b64_tr_b16 v[108:109], v3 offset:2048
  ds_read_b64_tr_b16 v[110:111], v3 offset:2560
  s_bfe_u32 s32, s3, 262164
  s_lshl_b32 s32, s32, 12
  v_add_u32 v2, s32, v25
  v_add_u32 v3, s32, v26
  ds_read_b64_tr_b16 v[112:113], v2 offset:0
  ds_read_b64_tr_b16 v[114:115], v2 offset:512
  ds_read_b64_tr_b16 v[116:117], v3 offset:0
  ds_read_b64_tr_b16 v[118:119], v3 offset:512
  ds_read_b64_tr_b16 v[120:121], v2 offset:2048
  ds_read_b64_tr_b16 v[122:123], v2 offset:2560
  ds_read_b64_tr_b16 v[124:125], v3 offset:2048
  ds_read_b64_tr_b16 v[126:127], v3 offset:2560
  s_bfe_u32 s32, s3, 262168
  s_lshl_b32 s32, s32, 12
  v_add_u32 v2, s32, v25
  v_add_u32 v3, s32, v26
  ds_read_b64_tr_b16 v[128:129], v2 offset:0
  ds_read_b64_tr_b16 v[130:131], v2 offset:512
  ds_read_b64_tr_b16 v[132:133], v3 offset:0
  ds_read_b64_tr_b16 v[134:135], v3 offset:512
  ds_read_b64_tr_b16 v[136:137], v2 offset:2048
  ds_read_b64_tr_b16 v[138:139], v2 offset:2560
  ds_read_b64_tr_b16 v[140:141], v3 offset:2048
  ds_read_b64_tr_b16 v[142:143], v3 offset:2560
  s_bfe_u32 s32, s3, 262172
  s_lshl_b32 s32, s32, 12
  v_add_u32 v2, s32, v25
  v_add_u32 v3, s32, v26
  ds_read_b64_tr_b16 v[144:145], v2 offset:0
  ds_read_b64_tr_b16 v[146:147], v2 offset:512
  ds_read_b64_tr_b16 v[148:149], v3 offset:0
  ds_read_b64_tr_b16 v[150:151], v3 offset:512
  ds_read_b64_tr_b16 v[152:153], v2 offset:2048
  ds_read_b64_tr_b16 v[154:155], v2 offset:2560
  ds_read_b64_tr_b16 v[156:157], v3 offset:2048
  ds_read_b64_tr_b16 v[158:159], v3 offset:2560
  s_lshl_b32 s60, s58, 1
  s_add_u32 s60, s60, s59
  s_lshl_b32 s61, s57, 2
  s_xor_b32 s32, s60, 1
  s_add_u32 s32, s32, s61
  s_mul_i32 s32, s32, 3
  s_add_u32 s32, s32, 0
  s_lshl_b32 s32, s32, 11
  s_add_u32 s32, s32, 32768
  v_add_u32 v9, s32, v7
  s_xor_b32 s32, s60, 2
  s_add_u32 s32, s32, s61
  s_mul_i32 s32, s32, 3
  s_add_u32 s32, s32, 1
  s_lshl_b32 s32, s32, 11
  s_add_u32 s32, s32, 32768
  v_add_u32 v10, s32, v7
  s_xor_b32 s32, s60, 3
  s_add_u32 s32, s32, s61
  s_mul_i32 s32, s32, 3
  s_add_u32 s32, s32, 2
  s_lshl_b32 s32, s32, 11
  s_add_u32 s32, s32, 32768
  v_add_u32 v11, s32, v7
  s_add_u32 s32, s60, s61
  s_mul_i32 s32, s32, 3
  s_lshl_b32 s32, s32, 11
  s_add_u32 s32, s32, 32768
  v_add_u32 v14, s32, v7
  s_mov_b32 s20, s42
  s_and_b32 s21, s43, 0xffff
  s_mov_b32 s22, 1835008
  s_mov_b32 s23, 0x20000
  s_waitcnt lgkmcnt(0)
  buffer_load_dwordx2 v[12:13], v28, s[24:27], 0 offen sc1
  s_bfe_u32 s32, s3, 262144
  s_lshl_b32 s32, s32, 11
  s_add_u32 s32, s32, s36
  buffer_load_dwordx4 v[160:163], v7, s[24:27], s32 offen sc1
  buffer_load_dwordx4 v[164:167], v7, s[24:27], s32 offen offset:1024 sc1
  s_bfe_u32 s32, s3, 262148
  s_lshl_b32 s32, s32, 11
  s_add_u32 s32, s32, s36
  buffer_load_dwordx4 v[168:171], v7, s[24:27], s32 offen sc1
  buffer_load_dwordx4 v[172:175], v7, s[24:27], s32 offen offset:1024 sc1
  s_bfe_u32 s32, s3, 262152
  s_lshl_b32 s32, s32, 11
  s_add_u32 s32, s32, s36
  buffer_load_dwordx4 v[176:179], v7, s[24:27], s32 offen sc1
  buffer_load_dwordx4 v[180:183], v7, s[24:27], s32 offen offset:1024 sc1
  s_barrier
  s_waitcnt vmcnt(4)
  s_bfe_u32 s32, s3, 262156
  s_lshl_b32 s32, s32, 11
  s_add_u32 s32, s32, s36
  buffer_load_dwordx4 v[184:187], v7, s[24:27], s32 offen sc1
  buffer_load_dwordx4 v[188:191], v7, s[24:27], s32 offen offset:1024 sc1
  v_xor_b32 v30, s49, v163
  v_xor_b32 v4, s49, v167
  v_or_b32 v30, v30, v4
  v_cmp_lt_u32 vcc, 0xffff, v30
  s_cbranch_vccnz L_ff_21
  v_mfma_f32_32x32x16_bf16 v[224:239], v[32:35], v[160:163], v[224:239]
  v_mfma_f32_32x32x16_bf16 v[240:255], v[36:39], v[160:163], v[240:255]
  v_mfma_f32_32x32x16_bf16 v[224:239], v[40:43], v[164:167], v[224:239]
  v_mfma_f32_32x32x16_bf16 v[240:255], v[44:47], v[164:167], v[240:255]
  s_bitset1_b32 s55, 0
  s_branch L_fp_20
L_ff_21:
  s_bfe_u32 s32, s3, 262144
  s_lshl_b32 s32, s32, 11
  s_add_u32 s32, s32, s36
  buffer_load_dwordx4 v[160:163], v7, s[24:27], s32 offen sc1
  buffer_load_dwordx4 v[164:167], v7, s[24:27], s32 offen offset:1024 sc1
L_fp_20:
  s_waitcnt vmcnt(4)
  s_bfe_u32 s32, s3, 262160
  s_lshl_b32 s32, s32, 11
  s_add_u32 s32, s32, s36
  buffer_load_dwordx4 v[192:195], v7, s[24:27], s32 offen sc1
  buffer_load_dwordx4 v[196:199], v7, s[24:27], s32 offen offset:1024 sc1
  v_xor_b32 v30, s49, v171
  v_xor_b32 v4, s49, v175
  v_or_b32 v30, v30, v4
  v_cmp_lt_u32 vcc, 0xffff, v30
  s_cbranch_vccnz L_ff_23
  v_mfma_f32_32x32x16_bf16 v[224:239], v[48:51], v[168:171], v[224:239]
  v_mfma_f32_32x32x16_bf16 v[240:255], v[52:55], v[168:171], v[240:255]
  v_mfma_f32_32x32x16_bf16 v[224:239], v[56:59], v[172:175], v[224:239]
  v_mfma_f32_32x32x16_bf16 v[240:255], v[60:63], v[172:175], v[240:255]
  s_bitset1_b32 s55, 1
  s_branch L_fp_22
L_ff_23:
  s_bfe_u32 s32, s3, 262148
  s_lshl_b32 s32, s32, 11
  s_add_u32 s32, s32, s36
  buffer_load_dwordx4 v[168:171], v7, s[24:27], s32 offen sc1
  buffer_load_dwordx4 v[172:175], v7, s[24:27], s32 offen offset:1024 sc1
L_fp_22:
  s_waitcnt vmcnt(4)
  s_bfe_u32 s32, s3, 262164
  s_lshl_b32 s32, s32, 11
  s_add_u32 s32, s32, s36
  buffer_load_dwordx4 v[200:203], v7, s[24:27], s32 offen sc1
  buffer_load_dwordx4 v[204:207], v7, s[24:27], s32 offen offset:1024 sc1
  v_xor_b32 v30, s49, v179
  v_xor_b32 v4, s49, v183
  v_or_b32 v30, v30, v4
  v_cmp_lt_u32 vcc, 0xffff, v30
  s_cbranch_vccnz L_ff_25
  v_mfma_f32_32x32x16_bf16 v[224:239], v[64:67], v[176:179], v[224:239]
  v_mfma_f32_32x32x16_bf16 v[240:255], v[68:71], v[176:179], v[240:255]
  v_mfma_f32_32x32x16_bf16 v[224:239], v[72:75], v[180:183], v[224:239]
  v_mfma_f32_32x32x16_bf16 v[240:255], v[76:79], v[180:183], v[240:255]
  s_bitset1_b32 s55, 2
  s_branch L_fp_24
L_ff_25:
  s_bfe_u32 s32, s3, 262152
  s_lshl_b32 s32, s32, 11
  s_add_u32 s32, s32, s36
  buffer_load_dwordx4 v[176:179], v7, s[24:27], s32 offen sc1
  buffer_load_dwordx4 v[180:183], v7, s[24:27], s32 offen offset:1024 sc1
L_fp_24:
  s_waitcnt vmcnt(4)
  s_bfe_u32 s32, s3, 262168
  s_lshl_b32 s32, s32, 11
  s_add_u32 s32, s32, s36
  buffer_load_dwordx4 v[208:211], v7, s[24:27], s32 offen sc1
  buffer_load_dwordx4 v[212:215], v7, s[24:27], s32 offen offset:1024 sc1
  v_xor_b32 v30, s49, v187
  v_xor_b32 v4, s49, v191
  v_or_b32 v30, v30, v4
  v_cmp_lt_u32 vcc, 0xffff, v30
  s_cbranch_vccnz L_ff_27
  v_mfma_f32_32x32x16_bf16 v[224:239], v[80:83], v[184:187], v[224:239]
  v_mfma_f32_32x32x16_bf16 v[240:255], v[84:87], v[184:187], v[240:255]
  v_mfma_f32_32x32x16_bf16 v[224:239], v[88:91], v[188:191], v[224:239]
  v_mfma_f32_32x32x16_bf16 v[240:255], v[92:95], v[188:191], v[240:255]
  s_bitset1_b32 s55, 3
  s_branch L_fp_26
L_ff_27:
  s_bfe_u32 s32, s3, 262156
  s_lshl_b32 s32, s32, 11
  s_add_u32 s32, s32, s36
  buffer_load_dwordx4 v[184:187], v7, s[24:27], s32 offen sc1
  buffer_load_dwordx4 v[188:191], v7, s[24:27], s32 offen offset:1024 sc1
L_fp_26:
  s_waitcnt vmcnt(4)
  s_bfe_u32 s32, s3, 262172
  s_lshl_b32 s32, s32, 11
  s_add_u32 s32, s32, s36
  buffer_load_dwordx4 v[216:219], v7, s[24:27], s32 offen sc1
  buffer_load_dwordx4 v[220:223], v7, s[24:27], s32 offen offset:1024 sc1
  v_xor_b32 v30, s49, v195
  v_xor_b32 v4, s49, v199
  v_or_b32 v30, v30, v4
  v_cmp_lt_u32 vcc, 0xffff, v30
  s_cbranch_vccnz L_ff_29
  v_mfma_f32_32x32x16_bf16 v[224:239], v[96:99], v[192:195], v[224:239]
  v_mfma_f32_32x32x16_bf16 v[240:255], v[100:103], v[192:195], v[240:255]
  v_mfma_f32_32x32x16_bf16 v[224:239], v[104:107], v[196:199], v[224:239]
  v_mfma_f32_32x32x16_bf16 v[240:255], v[108:111], v[196:199], v[240:255]
  s_bitset1_b32 s55, 4
  s_branch L_fp_28
L_ff_29:
  s_bfe_u32 s32, s3, 262160
  s_lshl_b32 s32, s32, 11
  s_add_u32 s32, s32, s36
  buffer_load_dwordx4 v[192:195], v7, s[24:27], s32 offen sc1
  buffer_load_dwordx4 v[196:199], v7, s[24:27], s32 offen offset:1024 sc1
L_fp_28:
  s_waitcnt vmcnt(4)
  v_xor_b32 v30, s49, v203
  v_xor_b32 v4, s49, v207
  v_or_b32 v30, v30, v4
  v_cmp_lt_u32 vcc, 0xffff, v30
  s_cbranch_vccnz L_ff_31
  v_mfma_f32_32x32x16_bf16 v[224:239], v[112:115], v[200:203], v[224:239]
  v_mfma_f32_32x32x16_bf16 v[240:255], v[116:119], v[200:203], v[240:255]
  v_mfma_f32_32x32x16_bf16 v[224:239], v[120:123], v[204:207], v[224:239]
  v_mfma_f32_32x32x16_bf16 v[240:255], v[124:127], v[204:207], v[240:255]
  s_bitset1_b32 s55, 5
  s_branch L_fp_30
L_ff_31:
  s_bfe_u32 s32, s3, 262164
  s_lshl_b32 s32, s32, 11
  s_add_u32 s32, s32, s36
  buffer_load_dwordx4 v[200:203], v7, s[24:27], s32 offen sc1
  buffer_load_dwordx4 v[204:207], v7, s[24:27], s32 offen offset:1024 sc1
L_fp_30:
  s_waitcnt vmcnt(2)
  v_xor_b32 v30, s49, v211
  v_xor_b32 v4, s49, v215
  v_or_b32 v30, v30, v4
  v_cmp_lt_u32 vcc, 0xffff, v30
  s_cbranch_vccnz L_ff_33
  v_mfma_f32_32x32x16_bf16 v[224:239], v[128:131], v[208:211], v[224:239]
  v_mfma_f32_32x32x16_bf16 v[240:255], v[132:135], v[208:211], v[240:255]
  v_mfma_f32_32x32x16_bf16 v[224:239], v[136:139], v[212:215], v[224:239]
  v_mfma_f32_32x32x16_bf16 v[240:255], v[140:143], v[212:215], v[240:255]
  s_bitset1_b32 s55, 6
  s_branch L_fp_32
L_ff_33:
  s_bfe_u32 s32, s3, 262168
  s_lshl_b32 s32, s32, 11
  s_add_u32 s32, s32, s36
  buffer_load_dwordx4 v[208:211], v7, s[24:27], s32 offen sc1
  buffer_load_dwordx4 v[212:215], v7, s[24:27], s32 offen offset:1024 sc1
L_fp_32:
  s_waitcnt vmcnt(0)
  v_xor_b32 v30, s49, v219
  v_xor_b32 v4, s49, v223
  v_or_b32 v30, v30, v4
  v_cmp_lt_u32 vcc, 0xffff, v30
  s_cbranch_vccnz L_ff_35
  v_mfma_f32_32x32x16_bf16 v[224:239], v[144:147], v[216:219], v[224:239]
  v_mfma_f32_32x32x16_bf16 v[240:255], v[148:151], v[216:219], v[240:255]
  v_mfma_f32_32x32x16_bf16 v[224:239], v[152:155], v[220:223], v[224:239]
  v_mfma_f32_32x32x16_bf16 v[240:255], v[156:159], v[220:223], v[240:255]
  s_bitset1_b32 s55, 7
  s_branch L_fp_34
L_ff_35:
  s_bfe_u32 s32, s3, 262172
  s_lshl_b32 s32, s32, 11
  s_add_u32 s32, s32, s36
  buffer_load_dwordx4 v[216:219], v7, s[24:27], s32 offen sc1
  buffer_load_dwordx4 v[220:223], v7, s[24:27], s32 offen offset:1024 sc1
L_fp_34:
L_df:
  s_cmp_eq_u32 s55, 0xff
  s_cbranch_scc1 L_dfdone
  s_sub_u32 s37, s37, 1
  s_cmp_eq_u32 s37, 0
  s_cbranch_scc1 L_dfdone
  s_waitcnt vmcnt(0)
  s_bitcmp1_b32 s55, 0
  s_cbranch_scc1 L_pr_36
  v_xor_b32 v30, s49, v163
  v_xor_b32 v2, s49, v167
  v_or_b32 v30, v30, v2
  v_cmp_lt_u32 vcc, 0xffff, v30
  s_cbranch_vccnz L_pf_37
  v_mfma_f32_32x32x16_bf16 v[224:239], v[32:35], v[160:163], v[224:239]
  v_mfma_f32_32x32x16_bf16 v[240:255], v[36:39], v[160:163], v[240:255]
  v_mfma_f32_32x32x16_bf16 v[224:239], v[40:43], v[164:167], v[224:239]
  v_mfma_f32_32x32x16_bf16 v[240:255], v[44:47], v[164:167], v[240:255]
  s_bitset1_b32 s55, 0
  s_branch L_pr_36
L_pf_37:
  s_bfe_u32 s32, s3, 262144
  s_lshl_b32 s32, s32, 11
  s_add_u32 s32, s32, s36
  buffer_load_dwordx4 v[160:163], v7, s[24:27], s32 offen sc1
  buffer_load_dwordx4 v[164:167], v7, s[24:27], s32 offen offset:1024 sc1
L_pr_36:
  s_bitcmp1_b32 s55, 1
  s_cbranch_scc1 L_pr_38
  v_xor_b32 v30, s49, v171
  v_xor_b32 v2, s49, v175
  v_or_b32 v30, v30, v2
  v_cmp_lt_u32 vcc, 0xffff, v30
  s_cbranch_vccnz L_pf_39
  v_mfma_f32_32x32x16_bf16 v[224:239], v[48:51], v[168:171], v[224:239]
  v_mfma_f32_32x32x16_bf16 v[240:255], v[52:55], v[168:171], v[240:255]
  v_mfma_f32_32x32x16_bf16 v[224:239], v[56:59], v[172:175], v[224:239]
  v_mfma_f32_32x32x16_bf16 v[240:255], v[60:63], v[172:175], v[240:255]
  s_bitset1_b32 s55, 1
  s_branch L_pr_38
L_pf_39:
  s_bfe_u32 s32, s3, 262148
  s_lshl_b32 s32, s32, 11
  s_add_u32 s32, s32, s36
  buffer_load_dwordx4 v[168:171], v7, s[24:27], s32 offen sc1
  buffer_load_dwordx4 v[172:175], v7, s[24:27], s32 offen offset:1024 sc1
L_pr_38:
  s_bitcmp1_b32 s55, 2
  s_cbranch_scc1 L_pr_40
  v_xor_b32 v30, s49, v179
  v_xor_b32 v2, s49, v183
  v_or_b32 v30, v30, v2
  v_cmp_lt_u32 vcc, 0xffff, v30
  s_cbranch_vccnz L_pf_41
  v_mfma_f32_32x32x16_bf16 v[224:239], v[64:67], v[176:179], v[224:239]
  v_mfma_f32_32x32x16_bf16 v[240:255], v[68:71], v[176:179], v[240:255]
  v_mfma_f32_32x32x16_bf16 v[224:239], v[72:75], v[180:183], v[224:239]
  v_mfma_f32_32x32x16_bf16 v[240:255], v[76:79], v[180:183], v[240:255]
  s_bitset1_b32 s55, 2
  s_branch L_pr_40
L_pf_41:
  s_bfe_u32 s32, s3, 262152
  s_lshl_b32 s32, s32, 11
  s_add_u32 s32, s32, s36
  buffer_load_dwordx4 v[176:179], v7, s[24:27], s32 offen sc1
  buffer_load_dwordx4 v[180:183], v7, s[24:27], s32 offen offset:1024 sc1
L_pr_40:
  s_bitcmp1_b32 s55, 3
  s_cbranch_scc1 L_pr_42
  v_xor_b32 v30, s49, v187
  v_xor_b32 v2, s49, v191
  v_or_b32 v30, v30, v2
  v_cmp_lt_u32 vcc, 0xffff, v30
  s_cbranch_vccnz L_pf_43
  v_mfma_f32_32x32x16_bf16 v[224:239], v[80:83], v[184:187], v[224:239]
  v_mfma_f32_32x32x16_bf16 v[240:255], v[84:87], v[184:187], v[240:255]
  v_mfma_f32_32x32x16_bf16 v[224:239], v[88:91], v[188:191], v[224:239]
  v_mfma_f32_32x32x16_bf16 v[240:255], v[92:95], v[188:191], v[240:255]
  s_bitset1_b32 s55, 3
  s_branch L_pr_42
L_pf_43:
  s_bfe_u32 s32, s3, 262156
  s_lshl_b32 s32, s32, 11
  s_add_u32 s32, s32, s36
  buffer_load_dwordx4 v[184:187], v7, s[24:27], s32 offen sc1
  buffer_load_dwordx4 v[188:191], v7, s[24:27], s32 offen offset:1024 sc1
L_pr_42:
  s_bitcmp1_b32 s55, 4
  s_cbranch_scc1 L_pr_44
  v_xor_b32 v30, s49, v195
  v_xor_b32 v2, s49, v199
  v_or_b32 v30, v30, v2
  v_cmp_lt_u32 vcc, 0xffff, v30
  s_cbranch_vccnz L_pf_45
  v_mfma_f32_32x32x16_bf16 v[224:239], v[96:99], v[192:195], v[224:239]
  v_mfma_f32_32x32x16_bf16 v[240:255], v[100:103], v[192:195], v[240:255]
  v_mfma_f32_32x32x16_bf16 v[224:239], v[104:107], v[196:199], v[224:239]
  v_mfma_f32_32x32x16_bf16 v[240:255], v[108:111], v[196:199], v[240:255]
  s_bitset1_b32 s55, 4
  s_branch L_pr_44
L_pf_45:
  s_bfe_u32 s32, s3, 262160
  s_lshl_b32 s32, s32, 11
  s_add_u32 s32, s32, s36
  buffer_load_dwordx4 v[192:195], v7, s[24:27], s32 offen sc1
  buffer_load_dwordx4 v[196:199], v7, s[24:27], s32 offen offset:1024 sc1
L_pr_44:
  s_bitcmp1_b32 s55, 5
  s_cbranch_scc1 L_pr_46
  v_xor_b32 v30, s49, v203
  v_xor_b32 v2, s49, v207
  v_or_b32 v30, v30, v2
  v_cmp_lt_u32 vcc, 0xffff, v30
  s_cbranch_vccnz L_pf_47
  v_mfma_f32_32x32x16_bf16 v[224:239], v[112:115], v[200:203], v[224:239]
  v_mfma_f32_32x32x16_bf16 v[240:255], v[116:119], v[200:203], v[240:255]
  v_mfma_f32_32x32x16_bf16 v[224:239], v[120:123], v[204:207], v[224:239]
  v_mfma_f32_32x32x16_bf16 v[240:255], v[124:127], v[204:207], v[240:255]
  s_bitset1_b32 s55, 5
  s_branch L_pr_46
L_pf_47:
  s_bfe_u32 s32, s3, 262164
  s_lshl_b32 s32, s32, 11
  s_add_u32 s32, s32, s36
  buffer_load_dwordx4 v[200:203], v7, s[24:27], s32 offen sc1
  buffer_load_dwordx4 v[204:207], v7, s[24:27], s32 offen offset:1024 sc1
L_pr_46:
  s_bitcmp1_b32 s55, 6
  s_cbranch_scc1 L_pr_48
  v_xor_b32 v30, s49, v211
  v_xor_b32 v2, s49, v215
  v_or_b32 v30, v30, v2
  v_cmp_lt_u32 vcc, 0xffff, v30
  s_cbranch_vccnz L_pf_49
  v_mfma_f32_32x32x16_bf16 v[224:239], v[128:131], v[208:211], v[224:239]
  v_mfma_f32_32x32x16_bf16 v[240:255], v[132:135], v[208:211], v[240:255]
  v_mfma_f32_32x32x16_bf16 v[224:239], v[136:139], v[212:215], v[224:239]
  v_mfma_f32_32x32x16_bf16 v[240:255], v[140:143], v[212:215], v[240:255]
  s_bitset1_b32 s55, 6
  s_branch L_pr_48
L_pf_49:
  s_bfe_u32 s32, s3, 262168
  s_lshl_b32 s32, s32, 11
  s_add_u32 s32, s32, s36
  buffer_load_dwordx4 v[208:211], v7, s[24:27], s32 offen sc1
  buffer_load_dwordx4 v[212:215], v7, s[24:27], s32 offen offset:1024 sc1
L_pr_48:
  s_bitcmp1_b32 s55, 7
  s_cbranch_scc1 L_pr_50
  v_xor_b32 v30, s49, v219
  v_xor_b32 v2, s49, v223
  v_or_b32 v30, v30, v2
  v_cmp_lt_u32 vcc, 0xffff, v30
  s_cbranch_vccnz L_pf_51
  v_mfma_f32_32x32x16_bf16 v[224:239], v[144:147], v[216:219], v[224:239]
  v_mfma_f32_32x32x16_bf16 v[240:255], v[148:151], v[216:219], v[240:255]
  v_mfma_f32_32x32x16_bf16 v[224:239], v[152:155], v[220:223], v[224:239]
  v_mfma_f32_32x32x16_bf16 v[240:255], v[156:159], v[220:223], v[240:255]
  s_bitset1_b32 s55, 7
  s_branch L_pr_50
L_pf_51:
  s_bfe_u32 s32, s3, 262172
  s_lshl_b32 s32, s32, 11
  s_add_u32 s32, s32, s36
  buffer_load_dwordx4 v[216:219], v7, s[24:27], s32 offen sc1
  buffer_load_dwordx4 v[220:223], v7, s[24:27], s32 offen offset:1024 sc1
L_pr_50:
  s_branch L_df
L_dfdone:
  s_nop 7
  s_nop 1
  ds_write_b128 v9, v[232:235]
  ds_write_b128 v9, v[236:239] offset:1024
  ds_write_b128 v10, v[240:243]
  ds_write_b128 v10, v[244:247] offset:1024
  ds_write_b128 v11, v[248:251]
  ds_write_b128 v11, v[252:255] offset:1024
  s_mov_b32 s37, 65536
L_g:
  s_waitcnt vmcnt(0)
  v_cmp_ne_u32 vcc, s48, v13
  s_cbranch_vccz L_gok
  s_sub_u32 s37, s37, 1
  s_cmp_eq_u32 s37, 0
  s_cbranch_scc1 L_gok
  buffer_load_dwordx2 v[12:13], v28, s[24:27], 0 offen sc1
  s_branch L_g
L_gok:
  v_sub_f32 v16, 1.0, v12
  s_cmp_eq_u32 s58, 0
  s_cselect_b64 vcc, -1, 0
  v_cndmask_b32 v16, v16, v12, vcc
  v_sub_f32 v18, 1.0, v16
  s_waitcnt lgkmcnt(0)
  s_barrier
  ds_read_b128 v[40:43], v14 offset:0
  ds_read_b128 v[44:47], v14 offset:1024
  ds_read_b128 v[48:51], v14 offset:2048
  ds_read_b128 v[52:55], v14 offset:3072
  ds_read_b128 v[56:59], v14 offset:4096
  ds_read_b128 v[60:63], v14 offset:5120
  s_waitcnt lgkmcnt(4)
  v_pk_add_f32 v[32:33], v[224:225], v[40:41]
  v_pk_add_f32 v[34:35], v[226:227], v[42:43]
  v_pk_add_f32 v[36:37], v[228:229], v[44:45]
  v_pk_add_f32 v[38:39], v[230:231], v[46:47]
  s_waitcnt lgkmcnt(0)
  v_pk_add_f32 v[48:49], v[48:49], v[56:57]
  v_pk_add_f32 v[50:51], v[50:51], v[58:59]
  v_pk_add_f32 v[52:53], v[52:53], v[60:61]
  v_pk_add_f32 v[54:55], v[54:55], v[62:63]
  v_pk_mul_f32 v[32:33], v[32:33], v[16:17] op_sel_hi:[1,0]
  v_pk_mul_f32 v[34:35], v[34:35], v[16:17] op_sel_hi:[1,0]
  v_pk_mul_f32 v[36:37], v[36:37], v[16:17] op_sel_hi:[1,0]
  v_pk_mul_f32 v[38:39], v[38:39], v[16:17] op_sel_hi:[1,0]
  v_pk_fma_f32 v[32:33], v[48:49], v[18:19], v[32:33] op_sel_hi:[1,0,1]
  v_pk_fma_f32 v[34:35], v[50:51], v[18:19], v[34:35] op_sel_hi:[1,0,1]
  v_pk_fma_f32 v[36:37], v[52:53], v[18:19], v[36:37] op_sel_hi:[1,0,1]
  v_pk_fma_f32 v[38:39], v[54:55], v[18:19], v[38:39] op_sel_hi:[1,0,1]
  v_cvt_pk_bf16_f32 v64, v32, v33
  v_cvt_pk_bf16_f32 v65, v34, v35
  v_cvt_pk_bf16_f32 v66, v36, v37
  v_cvt_pk_bf16_f32 v67, v38, v39
  s_nop 1
  v_permlane32_swap_b32 v64, v66
  v_permlane32_swap_b32 v65, v67
  buffer_store_dwordx4 v[64:67], v29, s[20:23], 0 offen
  s_cmp_lg_u32 s2, 0
  s_cbranch_scc1 L_fin
  s_cmp_lg_u32 s31, 0
  s_cbranch_scc1 L_fin
  v_mov_b32 v30, 12
  v_mov_b32 v31, s48
  s_mov_b32 exec_hi, 0
  s_mov_b32 exec_lo, 1
  buffer_store_dword v31, v30, s[24:27], 0 offen
  s_mov_b64 exec, -1
L_fin:
L_end:
  s_endpgm

.section .rodata,"a"
.p2align 6
.amdhsa_kernel gated_mix__linear_kernel_hedgehog__linear_kernel_hedgehog__prompt_kernel
  .amdhsa_next_free_vgpr 256
  .amdhsa_next_free_sgpr 102
  .amdhsa_accum_offset 256
  .amdhsa_group_segment_fixed_size 0
  .amdhsa_kernarg_size 96
  .amdhsa_user_sgpr_count 2
  .amdhsa_user_sgpr_kernarg_segment_ptr 1
  .amdhsa_system_sgpr_workgroup_id_x 1
.end_amdhsa_kernel
```
